```python
import torch

def _softmax(x, axis=-1):
    return torch.softmax(x, dim=axis)
def _gelu(x):
    return torch.nn.functional.gelu(x, approximate="tanh")
def _silu(x):
    return torch.nn.functional.silu(x)
def _sigmoid(x):
    return torch.sigmoid(x)
def _layernorm(x, axis=-1, eps=1e-5):
    m = x.mean(dim=axis, keepdim=True)
    v = x.var(dim=axis, keepdim=True, unbiased=False)
    return (x - m) / torch.sqrt(v + eps)
def _scatter_add(tgt, idx, src, axis=0):
    return tgt.clone().index_add_(axis, idx, src)
def _segment_sum(src, seg, n):
    out = torch.zeros((n,) + src.shape[1:], dtype=src.dtype)
    return out.index_add_(0, seg, src)
def _pad(x, pw):
    flat = tuple(v for pair in reversed(pw) for v in pair)
    return torch.nn.functional.pad(x, flat)

kernel_name = 'recurrent_scan__compressed_kv_cla__dense_activation_gelu__decode'

def setup_inputs():

    _w = (lambda a: (lambda t: t.to(torch.bfloat16) if t.is_floating_point() else t)(torch.as_tensor(a)))
    def _A_setup():
        B, H, Sq, Sk, D, M = 2, 32, 1, 16384, 128, 512
        Dc = 4 * D
        return {
            "x": _w((lambda *s: torch.randn(*s, dtype=torch.bfloat16) * 0.1)(B, Sq, M)),
            "c_kv": _w((lambda *s: torch.randn(*s, dtype=torch.bfloat16) * 3.2)(B, Sk, Dc)),
            "w_q": _w((lambda *s: torch.randn(*s, dtype=torch.bfloat16) * 0.8)(M, H, D) * (M ** -0.5)),
            "w_uk": _w((lambda *s: torch.randn(*s, dtype=torch.bfloat16) * 0.8)(Dc, H, D) * (Dc ** -0.5)),
            "w_uv": _w((lambda *s: torch.randn(*s, dtype=torch.bfloat16) * 3.2)(Dc, H, D) * (Dc ** -0.5)),
            "w_o": _w((lambda *s: torch.randn(*s, dtype=torch.bfloat16) * 3.2)(H, D, M) * ((H * D) ** -0.5)),
        }
    _A_in = _A_setup()

    def _B_setup():
        B, S, D, F = 2, 1, 512, 1792
        return {
            "x": _w((lambda *s: torch.randn(*s, dtype=torch.bfloat16) * 0.1)(B, S, D)),
            "w1": _w((lambda *s: torch.randn(*s, dtype=torch.bfloat16) * 3.2)(D, F) * (D ** -0.5)),
            "b1": _w((lambda *s: torch.randn(*s, dtype=torch.bfloat16) * 3.2)(F) * 0.01),
            "w2": _w((lambda *s: torch.randn(*s, dtype=torch.bfloat16) * 3.2)(F, D) * (F ** -0.5)),
            "b2": _w((lambda *s: torch.randn(*s, dtype=torch.bfloat16) * 3.2)(D) * 0.01),
        }
    _B_in = _B_setup()

    return {
        "A_x": _A_in["x"],
        "A_c_kv": _A_in["c_kv"],
        "A_w_q": _A_in["w_q"],
        "A_w_uk": _A_in["w_uk"],
        "A_w_uv": _A_in["w_uv"],
        "A_w_o": _A_in["w_o"],
        "B_x": _B_in["x"],
        "B_w1": _B_in["w1"],
        "B_b1": _B_in["b1"],
        "B_w2": _B_in["w2"],
        "B_b2": _B_in["b2"],
    }

def reference(A_x, A_c_kv, A_w_q, A_w_uk, A_w_uv, A_w_o, B_x, B_w1, B_b1, B_w2, B_b2):
    def _A_ref(x, c_kv, w_q, w_uk, w_uv, w_o):
        B, Sq, M = x.shape[0], x.shape[1], x.shape[2]
        Sk = c_kv.shape[1]
        H, D = w_q.shape[1], w_q.shape[2]
        q = torch.einsum("bqm,mhd->bhqd", x, w_q)
        k = torch.einsum("bkc,chd->bhkd", c_kv, w_uk)
        v = torch.einsum("bkc,chd->bhkd", c_kv, w_uv)
        scores = torch.einsum("bhqd,bhkd->bhqk", q, k) * (D ** -0.5)
        off = Sk - Sq
        qi = torch.arange(Sq)[:, None]
        kj = torch.arange(Sk)[None, :]
        cmask = kj <= (qi + off)
        scores = torch.where(cmask[None, None], scores, -1e9)
        p = _softmax(scores, axis=-1)
        ctx = torch.einsum("bhqk,bhkd->bhqd", p, v)
        return torch.einsum("bhqd,hdm->bqm", ctx, w_o)

    def _B_ref(x, w1, b1, w2, b2):
        h = torch.einsum("bsd,df->bsf", x, w1) + b1
        h = _gelu(h)
        return torch.einsum("bsf,fd->bsd", h, w2) + b2

    x = A_x
    xn = _layernorm(x, axis=-1)
    s = _A_ref(xn, A_c_kv, A_w_q, A_w_uk, A_w_uv, A_w_o)
    g = _silu(_B_ref(xn, B_w1, B_b1, B_w2, B_b2))
    return x + s * g
```

```asm
; @launch grid=(256,1,1) block=(512,1,1) lds=163840
.amdgcn_target "amdgcn-amd-amdhsa--gfx950"
.text
.globl recurrent_scan__compressed_kv_cla__dense_activation_gelu__decode_kernel
.p2align 8
.type recurrent_scan__compressed_kv_cla__dense_activation_gelu__decode_kernel,@function
recurrent_scan__compressed_kv_cla__dense_activation_gelu__decode_kernel:
    s_cmp_ge_u32 s2, 256
    s_cbranch_scc1 L_end
    s_load_dwordx16 s[64:79], s[0:1], 0
    s_load_dwordx8 s[80:87], s[0:1], 64
    s_load_dwordx4 s[88:91], s[0:1], 96
    s_getpc_b64 s[4:5]
L_pf:
    v_lshlrev_b32 v2, 6, v0
    v_cmp_gt_u32 vcc, L_codeend-L_pf, v2
    s_nop 0
    s_and_saveexec_b64 s[6:7], vcc
    s_cbranch_execz L_pfx
    global_load_dword v254, v2, s[4:5]
L_pfx:
    s_mov_b64 exec, -1
    v_lshrrev_b32 v2, 6, v0
    v_and_b32 v1, 63, v0
    v_readfirstlane_b32 s3, v2
    v_and_b32 v2, 15, v1
    v_lshrrev_b32 v3, 4, v1
    v_lshlrev_b32 v6, 4, v1
    s_and_b32 s35, s2, 7
    s_lshr_b32 s23, s2, 3
    s_and_b32 s93, s23, 3
    s_lshl_b32 s32, s35, 2
    s_add_u32 s32, s32, s93
    s_lshr_b32 s33, s2, 5
    v_lshlrev_b32 v26, 13, v3
    v_lshl_add_u32 v26, v2, 4, v26
    s_lshl_b32 s92, s32, 8
    v_add_u32 v26, s92, v26
    s_lshl_b32 s22, s33, 19
    s_sub_u32 s95, s3, 1
    s_lshl_b32 s95, s95, 10
    v_add_u32 v29, s95, v6
    s_mov_b32 s18, 0x400000
    s_mov_b32 s19, 0x00020000
    v_lshlrev_b32 v27, 14, v2
    v_lshl_add_u32 v27, v3, 4, v27
    s_add_u32 s92, s92, s22
    v_add_u32 v27, s92, v27
    s_cmp_lt_u32 s95, 2048
    s_waitcnt lgkmcnt(0)
    s_cbranch_scc0 L_nox
    global_load_dwordx4 v[40:43], v29, s[64:65]
L_nox:
    s_add_u32 s90, s90, 0
    s_addc_u32 s91, s91, 0
    s_mov_b32 s16, s68
    s_mov_b32 s17, s69
    s_cmp_lg_u32 s3, 0
    s_cbranch_scc1 L_now
    s_setprio 3
    buffer_load_dwordx4 v[64:67], v26, s[16:19], s22 offen nt
    s_add_u32 s22, s22, 32768
    buffer_load_dwordx4 v[68:71], v26, s[16:19], s22 offen nt
    s_add_u32 s22, s22, 32768
    buffer_load_dwordx4 v[72:75], v26, s[16:19], s22 offen nt
    s_add_u32 s22, s22, 32768
    buffer_load_dwordx4 v[76:79], v26, s[16:19], s22 offen nt
    s_add_u32 s22, s22, 32768
    buffer_load_dwordx4 v[80:83], v26, s[16:19], s22 offen nt
    s_add_u32 s22, s22, 32768
    buffer_load_dwordx4 v[84:87], v26, s[16:19], s22 offen nt
    s_add_u32 s22, s22, 32768
    buffer_load_dwordx4 v[88:91], v26, s[16:19], s22 offen nt
    s_add_u32 s22, s22, 32768
    buffer_load_dwordx4 v[92:95], v26, s[16:19], s22 offen nt
    s_add_u32 s22, s22, 32768
    buffer_load_dwordx4 v[96:99], v26, s[16:19], s22 offen nt
    s_add_u32 s22, s22, 32768
    buffer_load_dwordx4 v[100:103], v26, s[16:19], s22 offen nt
    s_add_u32 s22, s22, 32768
    buffer_load_dwordx4 v[104:107], v26, s[16:19], s22 offen nt
    s_add_u32 s22, s22, 32768
    buffer_load_dwordx4 v[108:111], v26, s[16:19], s22 offen nt
    s_add_u32 s22, s22, 32768
    buffer_load_dwordx4 v[112:115], v26, s[16:19], s22 offen nt
    s_add_u32 s22, s22, 32768
    buffer_load_dwordx4 v[116:119], v26, s[16:19], s22 offen nt
    s_add_u32 s22, s22, 32768
    buffer_load_dwordx4 v[120:123], v26, s[16:19], s22 offen nt
    s_add_u32 s22, s22, 32768
    buffer_load_dwordx4 v[124:127], v26, s[16:19], s22 offen nt
    global_load_dwordx4 v[192:195], v27, s[70:71] offset:0 nt
    global_load_dwordx4 v[196:199], v27, s[70:71] offset:64 nt
    global_load_dwordx4 v[200:203], v27, s[70:71] offset:128 nt
    global_load_dwordx4 v[204:207], v27, s[70:71] offset:192 nt
    v_add_u32 v27, 8192, v27
    global_load_dwordx4 v[208:211], v27, s[70:71] offset:0 nt
    global_load_dwordx4 v[212:215], v27, s[70:71] offset:64 nt
    global_load_dwordx4 v[216:219], v27, s[70:71] offset:128 nt
    global_load_dwordx4 v[220:223], v27, s[70:71] offset:192 nt
    v_add_u32 v27, 253952, v27
    global_load_dwordx4 v[224:227], v27, s[70:71] offset:0 nt
    global_load_dwordx4 v[228:231], v27, s[70:71] offset:64 nt
    global_load_dwordx4 v[232:235], v27, s[70:71] offset:128 nt
    global_load_dwordx4 v[236:239], v27, s[70:71] offset:192 nt
    v_add_u32 v27, 8192, v27
    global_load_dwordx4 v[240:243], v27, s[70:71] offset:0 nt
    global_load_dwordx4 v[244:247], v27, s[70:71] offset:64 nt
    global_load_dwordx4 v[248:251], v27, s[70:71] offset:128 nt
    global_load_dwordx4 v[252:255], v27, s[70:71] offset:192 nt
L_now:
    v_mov_b32 v9, 0
    v_mov_b32 v174, 0
    v_mov_b32 v175, 0
    v_mov_b32 v171, 0
    v_and_b32 v4, 7, v1
    v_lshrrev_b32 v5, 3, v1
    v_and_b32 v7, 31, v1
    v_lshrrev_b32 v8, 5, v1
    s_lshl_b32 s34, s35, 5
    s_add_u32 s34, s34, s23
    v_bfe_u32 v28, v5, 1, 1
    v_lshlrev_b32 v28, 2, v28
    v_lshrrev_b32 v31, 2, v5
    v_or_b32 v28, v28, v31
    v_xor_b32 v28, v28, v4
    v_lshlrev_b32 v31, 10, v5
    v_lshl_add_u32 v24, v28, 4, v31
    v_xor_b32 v25, 32, v24
    s_lshr_b32 s94, s34, 5
    s_lshl_b32 s94, s94, 9
    s_add_u32 s94, s94, 4096
    s_mov_b32 s7, s94
    s_and_b32 s93, s3, 3
    s_lshl_b32 s20, s2, 17
    s_lshl_b32 s92, s93, 15
    s_add_u32 s20, s20, s92
    s_lshl_b32 s21, s93, 12
    s_mov_b32 s8, s66
    s_mov_b32 s9, s67
    s_mov_b32 s10, 0x2000000
    s_mov_b32 s11, 0x00020000
    s_mov_b32 s14, 268435456
    s_mov_b32 s15, 0x00020000
    s_and_b32 s43, s23, 3
    s_lshl_b32 s43, s43, 3
    s_add_u32 s43, s43, s35
    s_lshl_b32 s23, s43, 3
    s_add_u32 s23, s23, s33
    s_cmp_lt_u32 s3, 4
    s_cbranch_scc1 L_nofb
    s_add_u32 m0, s21, 0
    s_add_u32 s92, s20, 0
    buffer_load_dwordx4 v24, s[8:11], s92 offen nt lds
L_nofb:
    s_mov_b32 s12, s90
    s_mov_b32 s13, s91
    s_load_dword s42, s[90:91], 0
    s_load_dword s41, s[90:91], s94
    s_cmp_lt_u32 s95, 2048
    s_cbranch_scc0 L_noln
    v_add_u32 v30, 131072, v29
    s_waitcnt vmcnt(0)
    v_lshlrev_b32 v44, 16, v40
    v_and_b32 v45, 0xffff0000, v40
    v_lshlrev_b32 v46, 16, v41
    v_and_b32 v47, 0xffff0000, v41
    v_lshlrev_b32 v48, 16, v42
    v_and_b32 v49, 0xffff0000, v42
    v_lshlrev_b32 v50, 16, v43
    v_and_b32 v51, 0xffff0000, v43
    v_add_f32 v52, v44, v45
    v_add_f32 v53, v46, v47
    v_add_f32 v54, v48, v49
    v_add_f32 v55, v50, v51
    v_add_f32 v52, v52, v53
    v_add_f32 v54, v54, v55
    v_add_f32 v52, v52, v54
    s_nop 1
    v_add_f32_dpp v52, v52, v52 row_ror:8 row_mask:0xf bank_mask:0xf
    s_nop 1
    v_add_f32_dpp v52, v52, v52 row_ror:4 row_mask:0xf bank_mask:0xf
    s_nop 1
    v_add_f32_dpp v52, v52, v52 row_ror:2 row_mask:0xf bank_mask:0xf
    s_nop 1
    v_add_f32_dpp v52, v52, v52 row_ror:1 row_mask:0xf bank_mask:0xf
    v_mov_b32 v53, v52
    s_nop 1
    v_permlane16_swap_b32 v52, v53
    v_add_f32 v52, v52, v53
    v_mov_b32 v53, v52
    s_nop 1
    v_permlane32_swap_b32 v52, v53
    v_add_f32 v52, v52, v53
    v_mul_f32 v52, 0x3b000000, v52
    v_cvt_pk_bf16_f32 v54, v52, v52
    v_sub_f32 v64, v44, v52
    v_sub_f32 v65, v45, v52
    v_sub_f32 v66, v46, v52
    v_sub_f32 v67, v47, v52
    v_sub_f32 v68, v48, v52
    v_sub_f32 v69, v49, v52
    v_sub_f32 v70, v50, v52
    v_sub_f32 v71, v51, v52
    v_and_b32 v54, 0xffff0000, v54
    v_mul_f32 v55, v64, v64
    v_mul_f32 v53, v65, v65
    v_fmac_f32 v55, v66, v66
    v_fmac_f32 v53, v67, v67
    v_fmac_f32 v55, v68, v68
    v_fmac_f32 v53, v69, v69
    v_fmac_f32 v55, v70, v70
    v_fmac_f32 v53, v71, v71
    v_add_f32 v55, v55, v53
    v_sub_f32 v44, v44, v54
    v_sub_f32 v45, v45, v54
    v_add_f32_dpp v55, v55, v55 row_ror:8 row_mask:0xf bank_mask:0xf
    v_sub_f32 v46, v46, v54
    v_sub_f32 v47, v47, v54
    v_add_f32_dpp v55, v55, v55 row_ror:4 row_mask:0xf bank_mask:0xf
    v_sub_f32 v48, v48, v54
    v_sub_f32 v49, v49, v54
    v_add_f32_dpp v55, v55, v55 row_ror:2 row_mask:0xf bank_mask:0xf
    v_sub_f32 v50, v50, v54
    v_sub_f32 v51, v51, v54
    v_add_f32_dpp v55, v55, v55 row_ror:1 row_mask:0xf bank_mask:0xf
    v_cvt_pk_bf16_f32 v40, v44, v45
    v_cvt_pk_bf16_f32 v41, v46, v47
    v_mov_b32 v53, v55
    v_cvt_pk_bf16_f32 v42, v48, v49
    v_cvt_pk_bf16_f32 v43, v50, v51
    v_permlane16_swap_b32 v55, v53
    v_lshlrev_b32 v44, 16, v40
    v_and_b32 v45, 0xffff0000, v40
    v_add_f32 v55, v55, v53
    v_mov_b32 v53, v55
    v_lshlrev_b32 v46, 16, v41
    v_and_b32 v47, 0xffff0000, v41
    v_permlane32_swap_b32 v55, v53
    v_lshlrev_b32 v48, 16, v42
    v_and_b32 v49, 0xffff0000, v42
    v_add_f32 v55, v55, v53
    v_mul_f32 v55, 0x3b000000, v55
    v_cvt_pk_bf16_f32 v55, v55, v55
    v_and_b32 v55, 0xffff0000, v55
    v_add_f32 v55, 0x3727c5ac, v55
    v_cvt_pk_bf16_f32 v55, v55, v55
    v_and_b32 v55, 0xffff0000, v55
    v_sqrt_f32 v55, v55
    v_lshlrev_b32 v50, 16, v43
    v_and_b32 v51, 0xffff0000, v43
    v_cvt_pk_bf16_f32 v55, v55, v55
    v_and_b32 v55, 0xffff0000, v55
    v_rcp_f32 v55, v55
    s_nop 0
    v_mul_f32 v44, v55, v44
    v_mul_f32 v45, v55, v45
    v_mul_f32 v46, v55, v46
    v_mul_f32 v47, v55, v47
    v_mul_f32 v48, v55, v48
    v_mul_f32 v49, v55, v49
    v_mul_f32 v50, v55, v50
    v_mul_f32 v51, v55, v51
    v_cvt_pk_bf16_f32 v40, v44, v45
    v_cvt_pk_bf16_f32 v41, v46, v47
    v_cvt_pk_bf16_f32 v42, v48, v49
    v_cvt_pk_bf16_f32 v43, v50, v51
    ds_write_b128 v30, v[40:43]
    s_waitcnt lgkmcnt(0)
    s_barrier
    s_mov_b32 s16, s72
    s_mov_b32 s17, s73
    v_lshlrev_b32 v56, 5, v3
    v_xor_b32 v56, v56, v26
    v_xor_b32 v57, 128, v56
    s_lshr_b32 s92, s95, 8
    s_lshl_b32 s93, s33, 6
    s_add_u32 s92, s92, s93
    s_lshl_b32 s92, s92, 13
    s_add_u32 s93, s92, 0
    buffer_load_dwordx4 v[208:211], v56, s[16:19], s93 offen nt
    s_add_u32 s93, s92, 65536
    buffer_load_dwordx4 v[212:215], v56, s[16:19], s93 offen nt
    s_add_u32 s93, s92, 131072
    buffer_load_dwordx4 v[216:219], v57, s[16:19], s93 offen nt
    s_add_u32 s93, s92, 196608
    buffer_load_dwordx4 v[220:223], v57, s[16:19], s93 offen nt
    s_add_u32 s93, s92, 262144
    buffer_load_dwordx4 v[224:227], v56, s[16:19], s93 offen nt
    s_add_u32 s93, s92, 327680
    buffer_load_dwordx4 v[228:231], v56, s[16:19], s93 offen nt
    s_add_u32 s93, s92, 393216
    buffer_load_dwordx4 v[232:235], v57, s[16:19], s93 offen nt
    s_add_u32 s93, s92, 458752
    buffer_load_dwordx4 v[236:239], v57, s[16:19], s93 offen nt
    v_and_b32 v56, 1, v4
    v_lshlrev_b32 v56, 4, v56
    v_lshlrev_b32 v56, v56, 1
    v_lshrrev_b32 v57, 1, v4
    v_cmp_eq_u32 vcc, 0, v57
    s_nop 1
    v_cndmask_b32 v20, 0, v56, vcc
    v_cmp_eq_u32 vcc, 1, v57
    s_nop 1
    v_cndmask_b32 v21, 0, v56, vcc
    v_cmp_eq_u32 vcc, 2, v57
    s_nop 1
    v_cndmask_b32 v22, 0, v56, vcc
    v_cmp_eq_u32 vcc, 3, v57
    s_nop 1
    v_cndmask_b32 v23, 0, v56, vcc
    v_mov_b32 v14, 1
    v_mov_b32 v15, 0xff
    s_waitcnt lgkmcnt(0)
    s_add_u32 s42, s42, 1
    s_and_b32 s37, s42, 0xff
    s_add_u32 s38, s42, 64
    s_and_b32 s38, s38, 0xff
    s_xor_b32 s39, s37, 0x80
    s_xor_b32 s40, s38, 0x80
    s_bfe_u32 s92, s42, 0x60008
    s_xor_b32 s38, s38, s92
    s_bfe_u32 s92, s42, 0x6000e
    s_xor_b32 s39, s39, s92
    s_bfe_u32 s92, s42, 0x60014
    s_xor_b32 s40, s40, s92
    s_lshl_b32 s36, s38, 8
    s_or_b32 s36, s36, s37
    s_lshl_b32 s92, s39, 16
    s_or_b32 s36, s36, s92
    s_lshl_b32 s92, s40, 24
    s_or_b32 s36, s36, s92
    v_and_b32 v58, 3, v1
    s_getreg_b32 s70, hwreg(HW_REG_XCC_ID, 0, 4)
    s_lshl_b32 s70, s70, 3
    v_lshlrev_b32 v56, 3, v58
    v_lshrrev_b32 v56, v56, s36
    v_bfe_u32 v10, v56, 0, 1
    v_bfe_u32 v11, v56, 2, 1
    v_bfe_u32 v12, v56, 4, 1
    v_bfe_u32 v13, v56, 6, 1
    v_lshlrev_b32 v56, 3, v58
    v_lshrrev_b32 v16, v56, s36
    s_lshl_b32 s92, s32, 3
    s_add_u32 s26, s92, s33
    s_lshl_b32 s92, s26, 10
    v_lshlrev_b32 v19, 6, v2
    v_lshl_add_u32 v19, v3, 4, v19
    v_add_u32 v19, s92, v19
    s_lshl_b32 s27, s3, 9
    s_add_u32 s27, s27, 8192
    v_lshlrev_b32 v17, 7, v1
    v_mul_u32_u24 v18, 0, v1
    s_barrier
    s_branch L_qdone
L_noln:
    v_and_b32 v56, 1, v4
    v_lshlrev_b32 v56, 4, v56
    v_lshlrev_b32 v56, v56, 1
    v_lshrrev_b32 v57, 1, v4
    v_cmp_eq_u32 vcc, 0, v57
    s_nop 1
    v_cndmask_b32 v20, 0, v56, vcc
    v_cmp_eq_u32 vcc, 1, v57
    s_nop 1
    v_cndmask_b32 v21, 0, v56, vcc
    v_cmp_eq_u32 vcc, 2, v57
    s_nop 1
    v_cndmask_b32 v22, 0, v56, vcc
    v_cmp_eq_u32 vcc, 3, v57
    s_nop 1
    v_cndmask_b32 v23, 0, v56, vcc
    v_mov_b32 v14, 1
    v_mov_b32 v15, 0xff
    s_waitcnt lgkmcnt(0)
    s_add_u32 s42, s42, 1
    s_and_b32 s37, s42, 0xff
    s_add_u32 s38, s42, 64
    s_and_b32 s38, s38, 0xff
    s_xor_b32 s39, s37, 0x80
    s_xor_b32 s40, s38, 0x80
    s_bfe_u32 s92, s42, 0x60008
    s_xor_b32 s38, s38, s92
    s_bfe_u32 s92, s42, 0x6000e
    s_xor_b32 s39, s39, s92
    s_bfe_u32 s92, s42, 0x60014
    s_xor_b32 s40, s40, s92
    s_lshl_b32 s36, s38, 8
    s_or_b32 s36, s36, s37
    s_lshl_b32 s92, s39, 16
    s_or_b32 s36, s36, s92
    s_lshl_b32 s92, s40, 24
    s_or_b32 s36, s36, s92
    v_and_b32 v58, 3, v1
    s_getreg_b32 s70, hwreg(HW_REG_XCC_ID, 0, 4)
    s_lshl_b32 s70, s70, 3
    v_lshlrev_b32 v56, 3, v58
    v_lshrrev_b32 v56, v56, s36
    v_bfe_u32 v10, v56, 0, 1
    v_bfe_u32 v11, v56, 2, 1
    v_bfe_u32 v12, v56, 4, 1
    v_bfe_u32 v13, v56, 6, 1
    v_lshlrev_b32 v56, 3, v58
    v_lshrrev_b32 v16, v56, s36
    s_lshl_b32 s92, s32, 3
    s_add_u32 s26, s92, s33
    s_lshl_b32 s92, s26, 10
    v_lshlrev_b32 v19, 6, v2
    v_lshl_add_u32 v19, v3, 4, v19
    v_add_u32 v19, s92, v19
    s_lshl_b32 s27, s3, 9
    s_add_u32 s27, s27, 8192
    v_lshlrev_b32 v17, 7, v1
    v_mul_u32_u24 v18, 0, v1
    s_cmp_lt_u32 s3, 4
    s_cbranch_scc1 L_qwave
    s_and_b32 s92, s3, 3
    s_lshl_b32 s24, s92, 10
    s_add_u32 s24, s24, 131072
    s_lshl_b32 s25, s92, 13
    s_lshr_b32 s94, s2, 7
    s_lshl_b32 s94, s94, 15
    s_add_u32 s25, s25, s94
    s_add_u32 s25, s25, 65536
    s_and_b32 s92, s3, 1
    s_lshl_b32 s92, s92, 5
    v_xor_b32 v27, s92, v24
    v_bfe_u32 v58, v27, 4, 2
    v_lshlrev_b32 v56, 3, v58
    v_lshrrev_b32 v56, v56, s36
    v_bfe_u32 v52, v56, 0, 1
    v_bfe_u32 v53, v56, 2, 1
    v_bfe_u32 v54, v56, 4, 1
    v_bfe_u32 v55, v56, 6, 1
    v_add_u32 v40, s24, v6
    s_barrier
    v_bfe_u32 v56, v1, 2, 2
    v_lshl_add_u32 v57, v8, 2, v56
    v_lshlrev_b32 v57, 7, v57
    v_and_b32 v58, 1, v1
    v_lshl_add_u32 v57, v58, 3, v57
    v_bfe_u32 v58, v1, 4, 1
    v_lshlrev_b32 v58, 1, v58
    v_bfe_u32 v59, v1, 1, 1
    v_or_b32 v58, v58, v59
    v_bfe_u32 v59, v1, 3, 1
    v_lshl_or_b32 v59, v59, 2, v8
    v_xor_b32 v58, v58, v59
    v_lshl_add_u32 v57, v58, 4, v57
    s_lshl_b32 s92, s3, 14
    v_add_u32 v28, s92, v57
    v_xor_b32 v29, 32, v28
    v_add_u32 v29, 1024, v29
    v_xor_b32 v30, 64, v28
    v_xor_b32 v31, 64, v29
    v_add_u32 v32, 139264, v6
    v_lshlrev_b32 v33, 4, v7
    v_add_u32 v33, 131072, v33
    v_and_b32 v34, 7, v7
    v_lshlrev_b32 v56, 2, v8
    v_xor_b32 v34, v34, v56
    v_lshlrev_b32 v34, 4, v34
    v_lshl_add_u32 v34, v7, 7, v34
    v_add_u32 v34, s92, v34
    v_xor_b32 v35, 16, v34
    v_xor_b32 v36, 32, v34
    v_xor_b32 v37, 48, v34
    v_xor_b32 v38, v4, v5
    v_lshlrev_b32 v38, 4, v38
    v_lshl_add_u32 v38, v5, 7, v38
    v_add_u32 v38, s92, v38
    v_lshlrev_b32 v39, 18, v5
    v_lshl_add_u32 v39, v4, 4, v39
    s_lshl_b32 s29, s3, 15
    s_lshl_b32 s92, s34, 7
    s_add_u32 s29, s29, s92
    s_add_u32 s29, s29, 8388608
    s_lshl_b32 s4, s26, 14
    s_lshl_b32 s92, s3, 7
    s_add_u32 s4, s4, s92
    s_lshl_b32 s5, s23, 14
    s_add_u32 s5, s5, s92
    s_bfe_u32 s6, s3, 0x10001
    s_lshl_b32 s6, s6, 5
    s_and_b32 s92, s3, 1
    s_lshl_b32 s92, s92, 4
    s_add_u32 s6, s6, s92
    s_lshr_b32 s92, s3, 2
    s_lshl_b32 s92, s92, 2
    s_add_u32 s6, s6, s92
    s_lshl_b32 s92, s33, 6
    s_add_u32 s6, s6, s92
    s_lshl_b32 s6, s6, 13
    s_lshl_b32 s92, s3, 3
    s_add_u32 s92, s92, 134656
    v_lshl_add_u32 v240, v8, 6, s92
    v_lshlrev_b32 v241, 3, v4
    v_lshl_add_u32 v241, v8, 6, v241
    v_add_u32 v241, 134656, v241
    v_and_b32 v56, 1, v3
    v_and_b32 v57, 3, v1
    v_lshl_add_u32 v248, v56, 2, v57
    v_lshlrev_b32 v248, 3, v248
    v_lshl_add_u32 v248, v8, 6, v248
    v_add_u32 v248, 134656, v248
    v_lshlrev_b32 v242, 11, v3
    v_bfe_u32 v56, v1, 2, 2
    v_lshl_add_u32 v242, v56, 8, v242
    v_lshl_add_u32 v242, v57, 3, v242
    v_and_b32 v58, 1, v3
    v_lshl_or_b32 v58, v58, 2, v56
    v_xor_b32 v58, s3, v58
    v_lshl_add_u32 v242, v58, 5, v242
    v_add_u32 v242, 147456, v242
    v_lshlrev_b32 v243, 9, v3
    v_lshl_add_u32 v243, v56, 7, v243
    v_lshl_add_u32 v243, v57, 3, v243
    s_lshl_b32 s92, s3, 14
    s_add_u32 s92, s92, 4096
    v_add_u32 v243, s92, v243
    v_mul_u32_u24 v244, 1152, v8
    v_lshl_add_u32 v244, v4, 4, v244
    v_and_b32 v56, 1, v3
    v_lshl_add_u32 v244, v56, 3, v244
    s_mul_i32 s92, s3, 144
    s_add_u32 s92, s92, 132096
    v_add_u32 v244, s92, v244
    v_mul_u32_u24 v245, 144, v2
    v_lshl_add_u32 v245, v3, 4, v245
    v_add_u32 v245, 132096, v245
    v_lshlrev_b32 v246, 6, v8
    v_lshl_add_u32 v246, v2, 2, v246
    s_lshl_b32 s92, s32, 3
    s_add_u32 s92, s92, s3
    s_lshl_b32 s92, s92, 3
    s_add_u32 s92, s92, s33
    s_lshl_b32 s92, s92, 7
    s_add_u32 s77, s92, 4456448
    s_add_u32 s76, s92, 4718592
    v_lshlrev_b32 v247, 11, v8
    v_lshl_add_u32 v247, v7, 2, v247
    s_lshl_b32 s66, s26, 15
    s_lshl_b32 s92, s3, 8
    s_add_u32 s66, s66, s92
    s_add_u32 s66, s66, 8388608
    v_and_b32 v58, 1, v1
    v_lshlrev_b32 v58, 5, v58
    v_lshl_add_u32 v249, v3, 3, v58
    v_add_u32 v249, 137472, v249
    s_xor_b32 s67, s23, 128
    s_lshl_b32 s67, s67, 12
    s_lshl_b32 s92, s3, 8
    s_add_u32 s67, s67, s92
    s_add_u32 s67, s67, 2097152
    v_lshlrev_b32 v250, 9, v5
    s_lshl_b32 s68, s3, 14
    s_lshl_b32 s92, s32, 4
    s_add_u32 s68, s68, s92
    s_add_u32 s68, s68, 3145728
    s_lshl_b32 s69, s26, 15
    s_lshl_b32 s92, s3, 12
    s_add_u32 s69, s69, s92
    s_add_u32 s69, s69, 8388608
    s_mov_b32 s31, 0
    s_cmp_lg_u32 s3, 7
    s_cbranch_scc1 L_nohx
    s_sub_u32 s92, s43, 16
    s_cmp_ge_u32 s92, 14
    s_cbranch_scc1 L_nohx
    s_mov_b32 s31, 1
    v_lshlrev_b32 v56, 10, v5
    v_bfe_u32 v57, v1, 2, 1
    v_lshl_add_u32 v56, v57, 9, v56
    v_and_b32 v57, 1, v1
    v_lshl_add_u32 v56, v57, 8, v56
    v_bfe_u32 v57, v1, 1, 1
    v_lshl_add_u32 v174, v57, 4, v56
    s_lshl_b32 s93, s92, 13
    s_lshl_b32 s94, s33, 5
    s_add_u32 s93, s93, s94
    s_add_u32 s93, s93, 5242880
    v_add_u32 v174, s93, v174
    s_lshl_b32 s92, s92, 8
    s_add_u32 s92, s92, s94
    v_lshl_add_u32 v175, v2, 1, s92
L_nohx:
    s_barrier
    s_branch L_loader
L_qwave:
    s_cmp_eq_u32 s3, 0
    s_cbranch_scc1 L_q0
    s_lshl_b32 s92, s32, 13
    s_add_u32 s92, s92, 4718592
    v_lshlrev_b32 v56, 7, v1
    buffer_load_dword v253, v56, s[12:15], s92 offen sc1
    s_mov_b32 s16, s78
    s_mov_b32 s17, s79
    s_mov_b32 s18, 1835008
    v_mul_u32_u24 v27, 3584, v3
    v_lshl_add_u32 v27, v2, 4, v27
    s_mul_i32 s22, s33, 229376
    s_lshl_b32 s92, s43, 8
    s_add_u32 s22, s22, s92
    s_lshl_b32 s25, s23, 10
    s_add_u32 s25, s25, 5242880
    v_and_b32 v58, 1, v5
    v_lshlrev_b32 v58, 10, v58
    v_lshl_add_u32 v58, v3, 1, v58
    s_lshl_b32 s92, s33, 7
    s_add_u32 s92, s92, 131072
    v_add_u32 v58, s92, v58
    s_barrier
    ds_read_u16 v28, v58 offset:0
    ds_read_u16 v29, v58 offset:8
    ds_read_u16 v30, v58 offset:16
    ds_read_u16 v31, v58 offset:24
    ds_read_u16 v32, v58 offset:32
    ds_read_u16 v33, v58 offset:40
    ds_read_u16 v34, v58 offset:48
    ds_read_u16 v35, v58 offset:56
    ds_read_u16 v36, v58 offset:64
    ds_read_u16 v37, v58 offset:72
    ds_read_u16 v38, v58 offset:80
    ds_read_u16 v39, v58 offset:88
    ds_read_u16 v40, v58 offset:96
    ds_read_u16 v41, v58 offset:104
    ds_read_u16 v42, v58 offset:112
    ds_read_u16 v43, v58 offset:120
    s_waitcnt lgkmcnt(0)
    s_barrier
    s_cmp_ge_u32 s43, 14
    s_cbranch_scc1 L_qdone
    buffer_load_dwordx4 v[64:67], v27, s[16:19], s22 offen nt
    s_add_u32 s22, s22, 14336
    buffer_load_dwordx4 v[68:71], v27, s[16:19], s22 offen nt
    s_add_u32 s22, s22, 14336
    buffer_load_dwordx4 v[72:75], v27, s[16:19], s22 offen nt
    s_add_u32 s22, s22, 14336
    buffer_load_dwordx4 v[76:79], v27, s[16:19], s22 offen nt
    s_add_u32 s22, s22, 14336
    buffer_load_dwordx4 v[80:83], v27, s[16:19], s22 offen nt
    s_add_u32 s22, s22, 14336
    buffer_load_dwordx4 v[84:87], v27, s[16:19], s22 offen nt
    s_add_u32 s22, s22, 14336
    buffer_load_dwordx4 v[88:91], v27, s[16:19], s22 offen nt
    s_add_u32 s22, s22, 14336
    buffer_load_dwordx4 v[92:95], v27, s[16:19], s22 offen nt
    s_add_u32 s22, s22, 14336
    buffer_load_dwordx4 v[96:99], v27, s[16:19], s22 offen nt
    s_add_u32 s22, s22, 14336
    buffer_load_dwordx4 v[100:103], v27, s[16:19], s22 offen nt
    s_add_u32 s22, s22, 14336
    buffer_load_dwordx4 v[104:107], v27, s[16:19], s22 offen nt
    s_add_u32 s22, s22, 14336
    buffer_load_dwordx4 v[108:111], v27, s[16:19], s22 offen nt
    s_add_u32 s22, s22, 14336
    buffer_load_dwordx4 v[112:115], v27, s[16:19], s22 offen nt
    s_add_u32 s22, s22, 14336
    buffer_load_dwordx4 v[116:119], v27, s[16:19], s22 offen nt
    s_add_u32 s22, s22, 14336
    buffer_load_dwordx4 v[120:123], v27, s[16:19], s22 offen nt
    s_add_u32 s22, s22, 14336
    buffer_load_dwordx4 v[124:127], v27, s[16:19], s22 offen nt
    s_waitcnt lgkmcnt(15)
    v_mul_u32_u24 v44, v28, v20
    v_mul_u32_u24 v45, v28, v21
    v_mul_u32_u24 v46, v28, v22
    v_mul_u32_u24 v47, v28, v23
    s_waitcnt vmcnt(15)
    s_nop 0
    v_mfma_f32_16x16x32_bf16 v[52:55], v[44:47], v[64:67], 0
    s_waitcnt lgkmcnt(14)
    v_mul_u32_u24 v48, v29, v20
    v_mul_u32_u24 v49, v29, v21
    v_mul_u32_u24 v50, v29, v22
    v_mul_u32_u24 v51, v29, v23
    s_waitcnt vmcnt(14)
    s_nop 0
    v_mfma_f32_16x16x32_bf16 v[52:55], v[48:51], v[68:71], v[52:55]
    s_waitcnt lgkmcnt(13)
    v_mul_u32_u24 v44, v30, v20
    v_mul_u32_u24 v45, v30, v21
    v_mul_u32_u24 v46, v30, v22
    v_mul_u32_u24 v47, v30, v23
    s_waitcnt vmcnt(13)
    s_nop 0
    v_mfma_f32_16x16x32_bf16 v[52:55], v[44:47], v[72:75], v[52:55]
    s_waitcnt lgkmcnt(12)
    v_mul_u32_u24 v48, v31, v20
    v_mul_u32_u24 v49, v31, v21
    v_mul_u32_u24 v50, v31, v22
    v_mul_u32_u24 v51, v31, v23
    s_waitcnt vmcnt(12)
    s_nop 0
    v_mfma_f32_16x16x32_bf16 v[52:55], v[48:51], v[76:79], v[52:55]
    s_waitcnt lgkmcnt(11)
    v_mul_u32_u24 v44, v32, v20
    v_mul_u32_u24 v45, v32, v21
    v_mul_u32_u24 v46, v32, v22
    v_mul_u32_u24 v47, v32, v23
    s_waitcnt vmcnt(11)
    s_nop 0
    v_mfma_f32_16x16x32_bf16 v[52:55], v[44:47], v[80:83], v[52:55]
    s_waitcnt lgkmcnt(10)
    v_mul_u32_u24 v48, v33, v20
    v_mul_u32_u24 v49, v33, v21
    v_mul_u32_u24 v50, v33, v22
    v_mul_u32_u24 v51, v33, v23
    s_waitcnt vmcnt(10)
    s_nop 0
    v_mfma_f32_16x16x32_bf16 v[52:55], v[48:51], v[84:87], v[52:55]
    s_waitcnt lgkmcnt(9)
    v_mul_u32_u24 v44, v34, v20
    v_mul_u32_u24 v45, v34, v21
    v_mul_u32_u24 v46, v34, v22
    v_mul_u32_u24 v47, v34, v23
    s_waitcnt vmcnt(9)
    s_nop 0
    v_mfma_f32_16x16x32_bf16 v[52:55], v[44:47], v[88:91], v[52:55]
    s_waitcnt lgkmcnt(8)
    v_mul_u32_u24 v48, v35, v20
    v_mul_u32_u24 v49, v35, v21
    v_mul_u32_u24 v50, v35, v22
    v_mul_u32_u24 v51, v35, v23
    s_waitcnt vmcnt(8)
    s_nop 0
    v_mfma_f32_16x16x32_bf16 v[52:55], v[48:51], v[92:95], v[52:55]
    s_waitcnt lgkmcnt(7)
    v_mul_u32_u24 v44, v36, v20
    v_mul_u32_u24 v45, v36, v21
    v_mul_u32_u24 v46, v36, v22
    v_mul_u32_u24 v47, v36, v23
    s_waitcnt vmcnt(7)
    s_nop 0
    v_mfma_f32_16x16x32_bf16 v[52:55], v[44:47], v[96:99], v[52:55]
    s_waitcnt lgkmcnt(6)
    v_mul_u32_u24 v48, v37, v20
    v_mul_u32_u24 v49, v37, v21
    v_mul_u32_u24 v50, v37, v22
    v_mul_u32_u24 v51, v37, v23
    s_waitcnt vmcnt(6)
    s_nop 0
    v_mfma_f32_16x16x32_bf16 v[52:55], v[48:51], v[100:103], v[52:55]
    s_waitcnt lgkmcnt(5)
    v_mul_u32_u24 v44, v38, v20
    v_mul_u32_u24 v45, v38, v21
    v_mul_u32_u24 v46, v38, v22
    v_mul_u32_u24 v47, v38, v23
    s_waitcnt vmcnt(5)
    s_nop 0
    v_mfma_f32_16x16x32_bf16 v[52:55], v[44:47], v[104:107], v[52:55]
    s_waitcnt lgkmcnt(4)
    v_mul_u32_u24 v48, v39, v20
    v_mul_u32_u24 v49, v39, v21
    v_mul_u32_u24 v50, v39, v22
    v_mul_u32_u24 v51, v39, v23
    s_waitcnt vmcnt(4)
    s_nop 0
    v_mfma_f32_16x16x32_bf16 v[52:55], v[48:51], v[108:111], v[52:55]
    s_waitcnt lgkmcnt(3)
    v_mul_u32_u24 v44, v40, v20
    v_mul_u32_u24 v45, v40, v21
    v_mul_u32_u24 v46, v40, v22
    v_mul_u32_u24 v47, v40, v23
    s_waitcnt vmcnt(3)
    s_nop 0
    v_mfma_f32_16x16x32_bf16 v[52:55], v[44:47], v[112:115], v[52:55]
    s_waitcnt lgkmcnt(2)
    v_mul_u32_u24 v48, v41, v20
    v_mul_u32_u24 v49, v41, v21
    v_mul_u32_u24 v50, v41, v22
    v_mul_u32_u24 v51, v41, v23
    s_waitcnt vmcnt(2)
    s_nop 0
    v_mfma_f32_16x16x32_bf16 v[52:55], v[48:51], v[116:119], v[52:55]
    s_waitcnt lgkmcnt(1)
    v_mul_u32_u24 v44, v42, v20
    v_mul_u32_u24 v45, v42, v21
    v_mul_u32_u24 v46, v42, v22
    v_mul_u32_u24 v47, v42, v23
    s_waitcnt vmcnt(1)
    s_nop 0
    v_mfma_f32_16x16x32_bf16 v[52:55], v[44:47], v[120:123], v[52:55]
    s_waitcnt lgkmcnt(0)
    v_mul_u32_u24 v48, v43, v20
    v_mul_u32_u24 v49, v43, v21
    v_mul_u32_u24 v50, v43, v22
    v_mul_u32_u24 v51, v43, v23
    s_waitcnt vmcnt(0)
    s_nop 0
    v_mfma_f32_16x16x32_bf16 v[52:55], v[48:51], v[124:127], v[52:55]
    s_nop 7
    v_bfi_b32 v52, v15, s37, v52
    v_bfi_b32 v53, v15, s38, v53
    v_bfi_b32 v54, v15, s39, v54
    v_bfi_b32 v55, v15, s40, v55
    buffer_store_dwordx4 v[52:55], v6, s[12:15], s25 offen sc1
    s_branch L_qdone
L_q0:
    v_and_b32 v58, 1, v5
    v_lshlrev_b32 v58, 10, v58
    v_lshl_add_u32 v58, v3, 1, v58
    s_lshl_b32 s92, s33, 7
    s_add_u32 s92, s92, 131072
    v_add_u32 v58, s92, v58
    s_lshl_b32 s24, s32, 13
    s_add_u32 s24, s24, 4718592
    s_lshl_b32 s25, s33, 10
    s_add_u32 s25, s25, s24
    s_add_u32 s30, s25, 262144
    s_add_u32 s31, s24, 262144
    v_lshlrev_b32 v61, 9, v2
    v_lshl_add_u32 v61, v3, 4, v61
    v_lshlrev_b32 v62, 15, v8
    v_lshl_add_u32 v62, v7, 2, v62
    v_bfe_u32 v56, v1, 2, 2
    v_lshlrev_b32 v56, 3, v56
    v_and_b32 v57, 3, v1
    v_lshl_add_u32 v56, v57, 1, v56
    v_lshrrev_b32 v56, v56, s36
    v_and_b32 v63, 1, v56
    v_lshlrev_b32 v63, 16, v63
    s_lshl_b32 s94, s32, 10
    s_lshl_b32 s93, s33, 7
    s_add_u32 s94, s94, s93
    s_add_u32 s94, s94, 65536
    s_mov_b32 s95, 0x3e0293ee
    s_barrier
    ds_read_u16 v28, v58 offset:0
    ds_read_u16 v29, v58 offset:8
    ds_read_u16 v30, v58 offset:16
    ds_read_u16 v31, v58 offset:24
    ds_read_u16 v32, v58 offset:32
    ds_read_u16 v33, v58 offset:40
    ds_read_u16 v34, v58 offset:48
    ds_read_u16 v35, v58 offset:56
    ds_read_u16 v36, v58 offset:64
    ds_read_u16 v37, v58 offset:72
    ds_read_u16 v38, v58 offset:80
    ds_read_u16 v39, v58 offset:88
    ds_read_u16 v40, v58 offset:96
    ds_read_u16 v41, v58 offset:104
    ds_read_u16 v42, v58 offset:112
    ds_read_u16 v43, v58 offset:120
    s_waitcnt lgkmcnt(15)
    v_mul_u32_u24 v44, v28, v20
    v_mul_u32_u24 v45, v28, v21
    v_mul_u32_u24 v46, v28, v22
    v_mul_u32_u24 v47, v28, v23
    s_waitcnt vmcnt(31)
    s_nop 0
    v_mfma_f32_16x16x32_bf16 v[52:55], v[44:47], v[64:67], 0
    s_waitcnt lgkmcnt(14)
    v_mul_u32_u24 v48, v29, v20
    v_mul_u32_u24 v49, v29, v21
    v_mul_u32_u24 v50, v29, v22
    v_mul_u32_u24 v51, v29, v23
    s_waitcnt vmcnt(30)
    s_nop 0
    v_mfma_f32_16x16x32_bf16 v[52:55], v[48:51], v[68:71], v[52:55]
    s_waitcnt lgkmcnt(13)
    v_mul_u32_u24 v44, v30, v20
    v_mul_u32_u24 v45, v30, v21
    v_mul_u32_u24 v46, v30, v22
    v_mul_u32_u24 v47, v30, v23
    s_waitcnt vmcnt(29)
    s_nop 0
    v_mfma_f32_16x16x32_bf16 v[52:55], v[44:47], v[72:75], v[52:55]
    s_waitcnt lgkmcnt(12)
    v_mul_u32_u24 v48, v31, v20
    v_mul_u32_u24 v49, v31, v21
    v_mul_u32_u24 v50, v31, v22
    v_mul_u32_u24 v51, v31, v23
    s_waitcnt vmcnt(28)
    s_nop 0
    v_mfma_f32_16x16x32_bf16 v[52:55], v[48:51], v[76:79], v[52:55]
    s_waitcnt lgkmcnt(11)
    v_mul_u32_u24 v44, v32, v20
    v_mul_u32_u24 v45, v32, v21
    v_mul_u32_u24 v46, v32, v22
    v_mul_u32_u24 v47, v32, v23
    s_waitcnt vmcnt(27)
    s_nop 0
    v_mfma_f32_16x16x32_bf16 v[52:55], v[44:47], v[80:83], v[52:55]
    s_waitcnt lgkmcnt(10)
    v_mul_u32_u24 v48, v33, v20
    v_mul_u32_u24 v49, v33, v21
    v_mul_u32_u24 v50, v33, v22
    v_mul_u32_u24 v51, v33, v23
    s_waitcnt vmcnt(26)
    s_nop 0
    v_mfma_f32_16x16x32_bf16 v[52:55], v[48:51], v[84:87], v[52:55]
    s_waitcnt lgkmcnt(9)
    v_mul_u32_u24 v44, v34, v20
    v_mul_u32_u24 v45, v34, v21
    v_mul_u32_u24 v46, v34, v22
    v_mul_u32_u24 v47, v34, v23
    s_waitcnt vmcnt(25)
    s_nop 0
    v_mfma_f32_16x16x32_bf16 v[52:55], v[44:47], v[88:91], v[52:55]
    s_waitcnt lgkmcnt(8)
    v_mul_u32_u24 v48, v35, v20
    v_mul_u32_u24 v49, v35, v21
    v_mul_u32_u24 v50, v35, v22
    v_mul_u32_u24 v51, v35, v23
    s_waitcnt vmcnt(24)
    s_nop 0
    v_mfma_f32_16x16x32_bf16 v[52:55], v[48:51], v[92:95], v[52:55]
    s_waitcnt lgkmcnt(7)
    v_mul_u32_u24 v44, v36, v20
    v_mul_u32_u24 v45, v36, v21
    v_mul_u32_u24 v46, v36, v22
    v_mul_u32_u24 v47, v36, v23
    s_waitcnt vmcnt(23)
    s_nop 0
    v_mfma_f32_16x16x32_bf16 v[52:55], v[44:47], v[96:99], v[52:55]
    s_waitcnt lgkmcnt(6)
    v_mul_u32_u24 v48, v37, v20
    v_mul_u32_u24 v49, v37, v21
    v_mul_u32_u24 v50, v37, v22
    v_mul_u32_u24 v51, v37, v23
    s_waitcnt vmcnt(22)
    s_nop 0
    v_mfma_f32_16x16x32_bf16 v[52:55], v[48:51], v[100:103], v[52:55]
    s_waitcnt lgkmcnt(5)
    v_mul_u32_u24 v44, v38, v20
    v_mul_u32_u24 v45, v38, v21
    v_mul_u32_u24 v46, v38, v22
    v_mul_u32_u24 v47, v38, v23
    s_waitcnt vmcnt(21)
    s_nop 0
    v_mfma_f32_16x16x32_bf16 v[52:55], v[44:47], v[104:107], v[52:55]
    s_waitcnt lgkmcnt(4)
    v_mul_u32_u24 v48, v39, v20
    v_mul_u32_u24 v49, v39, v21
    v_mul_u32_u24 v50, v39, v22
    v_mul_u32_u24 v51, v39, v23
    s_waitcnt vmcnt(20)
    s_nop 0
    v_mfma_f32_16x16x32_bf16 v[52:55], v[48:51], v[108:111], v[52:55]
    s_waitcnt lgkmcnt(3)
    v_mul_u32_u24 v44, v40, v20
    v_mul_u32_u24 v45, v40, v21
    v_mul_u32_u24 v46, v40, v22
    v_mul_u32_u24 v47, v40, v23
    s_waitcnt vmcnt(19)
    s_nop 0
    v_mfma_f32_16x16x32_bf16 v[52:55], v[44:47], v[112:115], v[52:55]
    s_waitcnt lgkmcnt(2)
    v_mul_u32_u24 v48, v41, v20
    v_mul_u32_u24 v49, v41, v21
    v_mul_u32_u24 v50, v41, v22
    v_mul_u32_u24 v51, v41, v23
    s_waitcnt vmcnt(18)
    s_nop 0
    v_mfma_f32_16x16x32_bf16 v[52:55], v[48:51], v[116:119], v[52:55]
    s_waitcnt lgkmcnt(1)
    v_mul_u32_u24 v44, v42, v20
    v_mul_u32_u24 v45, v42, v21
    v_mul_u32_u24 v46, v42, v22
    v_mul_u32_u24 v47, v42, v23
    s_waitcnt vmcnt(17)
    s_nop 0
    v_mfma_f32_16x16x32_bf16 v[52:55], v[44:47], v[120:123], v[52:55]
    s_waitcnt lgkmcnt(0)
    v_mul_u32_u24 v48, v43, v20
    v_mul_u32_u24 v49, v43, v21
    v_mul_u32_u24 v50, v43, v22
    v_mul_u32_u24 v51, v43, v23
    s_waitcnt vmcnt(16)
    s_nop 0
    v_mfma_f32_16x16x32_bf16 v[52:55], v[48:51], v[124:127], v[52:55]
    s_nop 7
    v_bfi_b32 v52, v15, s37, v52
    v_bfi_b32 v53, v15, s38, v53
    v_bfi_b32 v54, v15, s39, v54
    v_bfi_b32 v55, v15, s40, v55
    v_xor_b32 v44, s70, v52
    v_xor_b32 v45, s70, v53
    v_xor_b32 v46, s70, v54
    v_xor_b32 v47, s70, v55
    buffer_store_dwordx4 v[44:47], v6, s[12:15], s25 offen
    s_mov_b32 s71, s70
    s_mov_b32 s28, 0
    s_waitcnt vmcnt(0)
L_qx:
    s_xor_b32 s4, s37, s71
    s_xor_b32 s5, s38, s71
    s_xor_b32 s6, s39, s71
    s_xor_b32 s93, s40, s71
    buffer_load_dwordx4 v[64:67], v61, s[12:15], s24 offen offset:0 sc1
    buffer_load_dwordx4 v[68:71], v61, s[12:15], s24 offen offset:256 sc1
    buffer_load_dwordx4 v[72:75], v61, s[12:15], s24 offen offset:64 sc1
    buffer_load_dwordx4 v[76:79], v61, s[12:15], s24 offen offset:320 sc1
    buffer_load_dwordx4 v[80:83], v61, s[12:15], s24 offen offset:128 sc1
    buffer_load_dwordx4 v[84:87], v61, s[12:15], s24 offen offset:384 sc1
    buffer_load_dwordx4 v[88:91], v61, s[12:15], s24 offen offset:192 sc1
    buffer_load_dwordx4 v[92:95], v61, s[12:15], s24 offen offset:448 sc1
    s_cmp_lg_u32 s28, 0
    s_cbranch_scc1 L_norel
    s_barrier
L_norel:
    s_waitcnt vmcnt(0)
    v_xor_b32 v56, s4, v64
    v_xor_b32 v57, s4, v80
    v_bitop3_b32 v56, v65, s5, v56 bitop3:0xbe
    v_bitop3_b32 v57, v81, s5, v57 bitop3:0xbe
    v_bitop3_b32 v56, v66, s6, v56 bitop3:0xbe
    v_bitop3_b32 v57, v82, s6, v57 bitop3:0xbe
    v_bitop3_b32 v56, v67, s93, v56 bitop3:0xbe
    v_bitop3_b32 v57, v83, s93, v57 bitop3:0xbe
    v_bitop3_b32 v56, v68, s4, v56 bitop3:0xbe
    v_bitop3_b32 v57, v84, s4, v57 bitop3:0xbe
    v_bitop3_b32 v56, v69, s5, v56 bitop3:0xbe
    v_bitop3_b32 v57, v85, s5, v57 bitop3:0xbe
    v_bitop3_b32 v56, v70, s6, v56 bitop3:0xbe
    v_bitop3_b32 v57, v86, s6, v57 bitop3:0xbe
    v_bitop3_b32 v56, v71, s93, v56 bitop3:0xbe
    v_bitop3_b32 v57, v87, s93, v57 bitop3:0xbe
    v_bitop3_b32 v56, v72, s4, v56 bitop3:0xbe
    v_bitop3_b32 v57, v88, s4, v57 bitop3:0xbe
    v_bitop3_b32 v56, v73, s5, v56 bitop3:0xbe
    v_bitop3_b32 v57, v89, s5, v57 bitop3:0xbe
    v_bitop3_b32 v56, v74, s6, v56 bitop3:0xbe
    v_bitop3_b32 v57, v90, s6, v57 bitop3:0xbe
    v_bitop3_b32 v56, v75, s93, v56 bitop3:0xbe
    v_bitop3_b32 v57, v91, s93, v57 bitop3:0xbe
    v_bitop3_b32 v56, v76, s4, v56 bitop3:0xbe
    v_bitop3_b32 v57, v92, s4, v57 bitop3:0xbe
    v_bitop3_b32 v56, v77, s5, v56 bitop3:0xbe
    v_bitop3_b32 v57, v93, s5, v57 bitop3:0xbe
    v_bitop3_b32 v56, v78, s6, v56 bitop3:0xbe
    v_bitop3_b32 v57, v94, s6, v57 bitop3:0xbe
    v_bitop3_b32 v56, v79, s93, v56 bitop3:0xbe
    v_bitop3_b32 v57, v95, s93, v57 bitop3:0xbe
    v_or_b32 v56, v56, v57
    v_and_b32 v56, v15, v56
    v_cmp_ne_u32 vcc, 0, v56
    v_cvt_pk_bf16_f32 v96, v64, v65
    v_cvt_pk_bf16_f32 v97, v66, v67
    v_cvt_pk_bf16_f32 v98, v68, v69
    v_cvt_pk_bf16_f32 v99, v70, v71
    v_cvt_pk_bf16_f32 v100, v72, v73
    v_cvt_pk_bf16_f32 v101, v74, v75
    v_cvt_pk_bf16_f32 v102, v76, v77
    v_cvt_pk_bf16_f32 v103, v78, v79
    v_cvt_pk_bf16_f32 v104, v80, v81
    v_cvt_pk_bf16_f32 v105, v82, v83
    v_cvt_pk_bf16_f32 v106, v84, v85
    v_cvt_pk_bf16_f32 v107, v86, v87
    v_cvt_pk_bf16_f32 v108, v88, v89
    v_cvt_pk_bf16_f32 v109, v90, v91
    v_cvt_pk_bf16_f32 v110, v92, v93
    v_cvt_pk_bf16_f32 v111, v94, v95
    s_cbranch_vccz L_qxok
    s_add_u32 s28, s28, 1
    s_cmp_lt_u32 s28, 4
    s_cbranch_scc1 L_qx
    s_cmp_lg_u32 s28, 4
    s_cbranch_scc1 L_qx2
    buffer_store_dwordx4 v[52:55], v6, s[12:15], s30 offen sc1
L_qx2:
    s_xor_b32 s71, s71, s70
    s_xor_b32 s24, s24, 262144
    s_cmp_lt_u32 s28, 1048576
    s_cbranch_scc1 L_qx
    v_mov_b32 v60, 28
    v_mov_b32 v61, 1
    s_mov_b64 exec, 1
    global_atomic_add v60, v61, s[88:89]
    s_mov_b64 exec, -1
L_qxok:
    v_mfma_f32_16x16x32_bf16 v[112:115], v[96:99], v[192:195], 0
    v_mfma_f32_16x16x32_bf16 v[116:119], v[96:99], v[208:211], 0
    v_mfma_f32_16x16x32_bf16 v[120:123], v[96:99], v[224:227], 0
    v_mfma_f32_16x16x32_bf16 v[124:127], v[96:99], v[240:243], 0
    v_mfma_f32_16x16x32_bf16 v[112:115], v[100:103], v[196:199], v[112:115]
    v_mfma_f32_16x16x32_bf16 v[116:119], v[100:103], v[212:215], v[116:119]
    v_mfma_f32_16x16x32_bf16 v[120:123], v[100:103], v[228:231], v[120:123]
    v_mfma_f32_16x16x32_bf16 v[124:127], v[100:103], v[244:247], v[124:127]
    v_mfma_f32_16x16x32_bf16 v[112:115], v[104:107], v[200:203], v[112:115]
    v_mfma_f32_16x16x32_bf16 v[116:119], v[104:107], v[216:219], v[116:119]
    v_mfma_f32_16x16x32_bf16 v[120:123], v[104:107], v[232:235], v[120:123]
    v_mfma_f32_16x16x32_bf16 v[124:127], v[104:107], v[248:251], v[124:127]
    v_mfma_f32_16x16x32_bf16 v[112:115], v[108:111], v[204:207], v[112:115]
    v_mfma_f32_16x16x32_bf16 v[116:119], v[108:111], v[220:223], v[116:119]
    v_mfma_f32_16x16x32_bf16 v[120:123], v[108:111], v[236:239], v[120:123]
    v_mfma_f32_16x16x32_bf16 v[124:127], v[108:111], v[252:255], v[124:127]
    s_nop 4
    v_add_f32 v112, v112, v114
    v_add_f32 v113, v113, v115
    v_add_f32 v116, v116, v118
    v_add_f32 v117, v117, v119
    v_add_f32 v120, v120, v122
    v_add_f32 v121, v121, v123
    v_add_f32 v124, v124, v126
    v_add_f32 v125, v125, v127
    v_permlane32_swap_b32 v112, v113
    v_permlane32_swap_b32 v116, v117
    v_permlane32_swap_b32 v120, v121
    v_permlane32_swap_b32 v124, v125
    v_add_f32 v112, v112, v113
    v_add_f32 v116, v116, v117
    v_add_f32 v120, v120, v121
    v_add_f32 v124, v124, v125
    s_nop 0
    v_permlane16_swap_b32 v112, v120
    v_permlane16_swap_b32 v116, v124
    v_add_f32 v112, v112, v120
    v_add_f32 v116, v116, v124
    v_mul_f32 v112, s95, v112
    v_mul_f32 v116, s95, v116
    v_sub_u32 v112, v112, v63
    v_cvt_pk_bf16_f32 v116, 0, v116
    v_add_u32 v112, 0x10000, v112
    v_and_b32 v112, 0xfffe0000, v112
    v_or_b32 v112, v112, v63
    v_lshrrev_b32 v112, 16, v112
    v_or_b32 v112, v112, v116
    buffer_store_dword v112, v62, s[12:15], s94 offen sc1
    s_setprio 0
L_qdone:
    v_lshlrev_b32 v251, 10, v5
    v_lshl_add_u32 v251, v4, 4, v251
    s_lshl_b32 s92, s3, 7
    v_add_u32 v251, s92, v251
    s_lshl_b32 s92, s26, 14
    v_add_u32 v56, s92, v251
    v_add_u32 v57, 8192, v56
    global_load_dwordx4 v[176:179], v56, s[74:75] nt
    global_load_dwordx4 v[180:183], v57, s[74:75] nt
    s_sub_u32 s92, s43, 16
    s_cmp_ge_u32 s92, 14
    s_cbranch_scc1 L_nw21
    s_xor_b32 s92, s23, 128
    s_lshl_b32 s92, s92, 14
    v_add_u32 v56, s92, v251
    v_add_u32 v57, 8192, v56
    global_load_dwordx4 v[184:187], v56, s[82:83] nt
    global_load_dwordx4 v[188:191], v57, s[82:83] nt
L_nw21:
    v_bfe_u32 v56, v7, 1, 1
    v_lshlrev_b32 v56, 2, v56
    v_bfe_u32 v57, v7, 2, 2
    v_or_b32 v56, v56, v57
    v_xor_b32 v56, v56, v8
    v_lshlrev_b32 v56, 4, v56
    v_lshl_add_u32 v56, v7, 7, v56
    s_lshl_b32 s92, s3, 12
    v_xor_b32 v57, 0, v56
    v_add_u32 v40, s92, v57
    v_add_u32 v44, 0x10000, v40
    v_add_u32 v48, 131072, v57
    v_xor_b32 v57, 32, v56
    v_add_u32 v41, s92, v57
    v_add_u32 v45, 0x10000, v41
    v_add_u32 v49, 131072, v57
    v_xor_b32 v57, 64, v56
    v_add_u32 v42, s92, v57
    v_add_u32 v46, 0x10000, v42
    v_add_u32 v50, 131072, v57
    v_xor_b32 v57, 96, v56
    v_add_u32 v43, s92, v57
    v_add_u32 v47, 0x10000, v43
    v_add_u32 v51, 131072, v57
    v_bfe_u32 v56, v1, 2, 2
    v_lshl_add_u32 v57, v8, 2, v56
    v_lshlrev_b32 v57, 7, v57
    v_and_b32 v58, 1, v1
    v_lshl_add_u32 v57, v58, 3, v57
    v_bfe_u32 v58, v1, 4, 1
    v_lshlrev_b32 v58, 1, v58
    v_bfe_u32 v59, v1, 1, 1
    v_or_b32 v58, v58, v59
    v_bfe_u32 v59, v1, 3, 1
    v_lshl_or_b32 v59, v59, 2, v8
    v_xor_b32 v58, v58, v59
    v_lshl_add_u32 v57, v58, 4, v57
    s_lshl_b32 s92, s3, 14
    v_add_u32 v28, s92, v57
    v_xor_b32 v29, 32, v28
    v_add_u32 v29, 1024, v29
    v_xor_b32 v30, 64, v28
    v_xor_b32 v31, 64, v29
    v_add_u32 v32, 139264, v6
    v_lshlrev_b32 v33, 4, v7
    v_add_u32 v33, 131072, v33
    v_and_b32 v34, 7, v7
    v_lshlrev_b32 v56, 2, v8
    v_xor_b32 v34, v34, v56
    v_lshlrev_b32 v34, 4, v34
    v_lshl_add_u32 v34, v7, 7, v34
    v_add_u32 v34, s92, v34
    v_xor_b32 v35, 16, v34
    v_xor_b32 v36, 32, v34
    v_xor_b32 v37, 48, v34
    v_xor_b32 v38, v4, v5
    v_lshlrev_b32 v38, 4, v38
    v_lshl_add_u32 v38, v5, 7, v38
    v_add_u32 v38, s92, v38
    v_lshlrev_b32 v39, 18, v5
    v_lshl_add_u32 v39, v4, 4, v39
    s_lshl_b32 s29, s3, 15
    s_lshl_b32 s92, s34, 7
    s_add_u32 s29, s29, s92
    s_add_u32 s29, s29, 8388608
    s_lshl_b32 s4, s26, 14
    s_lshl_b32 s92, s3, 7
    s_add_u32 s4, s4, s92
    s_lshl_b32 s5, s23, 14
    s_add_u32 s5, s5, s92
    s_bfe_u32 s6, s3, 0x10001
    s_lshl_b32 s6, s6, 5
    s_and_b32 s92, s3, 1
    s_lshl_b32 s92, s92, 4
    s_add_u32 s6, s6, s92
    s_lshr_b32 s92, s3, 2
    s_lshl_b32 s92, s92, 2
    s_add_u32 s6, s6, s92
    s_lshl_b32 s92, s33, 6
    s_add_u32 s6, s6, s92
    s_lshl_b32 s6, s6, 13
    s_lshl_b32 s92, s3, 3
    s_add_u32 s92, s92, 134656
    v_lshl_add_u32 v240, v8, 6, s92
    v_lshlrev_b32 v241, 3, v4
    v_lshl_add_u32 v241, v8, 6, v241
    v_add_u32 v241, 134656, v241
    v_and_b32 v56, 1, v3
    v_and_b32 v57, 3, v1
    v_lshl_add_u32 v248, v56, 2, v57
    v_lshlrev_b32 v248, 3, v248
    v_lshl_add_u32 v248, v8, 6, v248
    v_add_u32 v248, 134656, v248
    v_lshlrev_b32 v242, 11, v3
    v_bfe_u32 v56, v1, 2, 2
    v_lshl_add_u32 v242, v56, 8, v242
    v_lshl_add_u32 v242, v57, 3, v242
    v_and_b32 v58, 1, v3
    v_lshl_or_b32 v58, v58, 2, v56
    v_xor_b32 v58, s3, v58
    v_lshl_add_u32 v242, v58, 5, v242
    v_add_u32 v242, 147456, v242
    v_lshlrev_b32 v243, 9, v3
    v_lshl_add_u32 v243, v56, 7, v243
    v_lshl_add_u32 v243, v57, 3, v243
    s_lshl_b32 s92, s3, 14
    s_add_u32 s92, s92, 4096
    v_add_u32 v243, s92, v243
    v_mul_u32_u24 v244, 1152, v8
    v_lshl_add_u32 v244, v4, 4, v244
    v_and_b32 v56, 1, v3
    v_lshl_add_u32 v244, v56, 3, v244
    s_mul_i32 s92, s3, 144
    s_add_u32 s92, s92, 132096
    v_add_u32 v244, s92, v244
    v_mul_u32_u24 v245, 144, v2
    v_lshl_add_u32 v245, v3, 4, v245
    v_add_u32 v245, 132096, v245
    v_lshlrev_b32 v246, 6, v8
    v_lshl_add_u32 v246, v2, 2, v246
    s_lshl_b32 s92, s32, 3
    s_add_u32 s92, s92, s3
    s_lshl_b32 s92, s92, 3
    s_add_u32 s92, s92, s33
    s_lshl_b32 s92, s92, 7
    s_add_u32 s77, s92, 4456448
    s_add_u32 s76, s92, 4718592
    v_lshlrev_b32 v247, 11, v8
    v_lshl_add_u32 v247, v7, 2, v247
    s_lshl_b32 s66, s26, 15
    s_lshl_b32 s92, s3, 8
    s_add_u32 s66, s66, s92
    s_add_u32 s66, s66, 8388608
    v_and_b32 v58, 1, v1
    v_lshlrev_b32 v58, 5, v58
    v_lshl_add_u32 v249, v3, 3, v58
    v_add_u32 v249, 137472, v249
    s_xor_b32 s67, s23, 128
    s_lshl_b32 s67, s67, 12
    s_lshl_b32 s92, s3, 8
    s_add_u32 s67, s67, s92
    s_add_u32 s67, s67, 2097152
    v_lshlrev_b32 v250, 9, v5
    s_lshl_b32 s68, s3, 14
    s_lshl_b32 s92, s32, 4
    s_add_u32 s68, s68, s92
    s_add_u32 s68, s68, 3145728
    s_lshl_b32 s69, s26, 15
    s_lshl_b32 s92, s3, 12
    s_add_u32 s69, s69, s92
    s_add_u32 s69, s69, 8388608
    s_lshl_b32 s92, s3, 2
    v_add_u32 v52, s92, v33
    s_lshl_b32 s92, s3, 11
    v_add_u32 v53, s92, v32
    v_lshlrev_b32 v171, 1, v7
    s_lshl_b32 s92, s2, 6
    s_and_b32 s92, s92, 2047
    v_add_u32 v171, s92, v171
    v_and_b32 v56, 1023, v171
    global_load_ushort v172, v171, s[64:65]
    global_load_ushort v173, v56, s[84:85]
    s_waitcnt vmcnt(0)
    s_barrier
    s_cmp_lg_u32 s3, 2
    s_cbranch_scc1 L_nopt
    s_mov_b32 s95, 4718592
    s_mov_b32 s95, 8192
    s_mov_b32 exec_lo, 0xffffffff
    s_mov_b32 exec_hi, 0x0
    buffer_load_dword v253, v17, s[12:15], s95 offen sc1
    s_mov_b64 exec, -1
L_nopt:
    ds_read_b128 v[64:67], v40 offset:0
    ds_read_b128 v[96:99], v48 offset:0
    ds_read_b128 v[68:71], v41 offset:0
    ds_read_b128 v[100:103], v49 offset:0
    ds_read_b128 v[72:75], v42 offset:0
    ds_read_b128 v[104:107], v50 offset:0
    ds_read_b128 v[76:79], v43 offset:0
    ds_read_b128 v[108:111], v51 offset:0
    ds_read_b128 v[80:83], v40 offset:16384
    ds_read_b128 v[112:115], v48 offset:4096
    ds_read_b128 v[84:87], v41 offset:16384
    ds_read_b128 v[116:119], v49 offset:4096
    s_waitcnt lgkmcnt(10)
    v_mfma_f32_32x32x16_bf16 v[128:143], v[64:67], v[96:99], 0
    ds_read_b128 v[88:91], v42 offset:16384
    ds_read_b128 v[120:123], v50 offset:4096
    s_waitcnt lgkmcnt(10)
    v_mfma_f32_32x32x16_bf16 v[128:143], v[68:71], v[100:103], v[128:143]
    ds_read_b128 v[92:95], v43 offset:16384
    ds_read_b128 v[124:127], v51 offset:4096
    s_waitcnt lgkmcnt(10)
    v_mfma_f32_32x32x16_bf16 v[128:143], v[72:75], v[104:107], v[128:143]
    ds_read_b128 v[64:67], v40 offset:32768
    ds_read_b128 v[96:99], v48 offset:8192
    s_waitcnt lgkmcnt(10)
    v_mfma_f32_32x32x16_bf16 v[128:143], v[76:79], v[108:111], v[128:143]
    ds_read_b128 v[68:71], v41 offset:32768
    ds_read_b128 v[100:103], v49 offset:8192
    s_waitcnt lgkmcnt(10)
    v_mfma_f32_32x32x16_bf16 v[128:143], v[80:83], v[112:115], v[128:143]
    ds_read_b128 v[72:75], v42 offset:32768
    ds_read_b128 v[104:107], v50 offset:8192
    s_waitcnt lgkmcnt(10)
    v_mfma_f32_32x32x16_bf16 v[128:143], v[84:87], v[116:119], v[128:143]
    ds_read_b128 v[76:79], v43 offset:32768
    ds_read_b128 v[108:111], v51 offset:8192
    s_waitcnt lgkmcnt(10)
    v_mfma_f32_32x32x16_bf16 v[128:143], v[88:91], v[120:123], v[128:143]
    ds_read_b128 v[80:83], v40 offset:49152
    ds_read_b128 v[112:115], v48 offset:12288
    s_waitcnt lgkmcnt(10)
    v_mfma_f32_32x32x16_bf16 v[128:143], v[92:95], v[124:127], v[128:143]
    ds_read_b128 v[84:87], v41 offset:49152
    ds_read_b128 v[116:119], v49 offset:12288
    s_waitcnt lgkmcnt(10)
    v_mfma_f32_32x32x16_bf16 v[128:143], v[64:67], v[96:99], v[128:143]
    ds_read_b128 v[88:91], v42 offset:49152
    ds_read_b128 v[120:123], v50 offset:12288
    s_waitcnt lgkmcnt(10)
    v_mfma_f32_32x32x16_bf16 v[128:143], v[68:71], v[100:103], v[128:143]
    ds_read_b128 v[92:95], v43 offset:49152
    ds_read_b128 v[124:127], v51 offset:12288
    s_waitcnt lgkmcnt(10)
    v_mfma_f32_32x32x16_bf16 v[128:143], v[72:75], v[104:107], v[128:143]
    ds_read_b128 v[64:67], v44 offset:0
    ds_read_b128 v[96:99], v48 offset:16384
    s_waitcnt lgkmcnt(10)
    v_mfma_f32_32x32x16_bf16 v[128:143], v[76:79], v[108:111], v[128:143]
    ds_read_b128 v[68:71], v45 offset:0
    ds_read_b128 v[100:103], v49 offset:16384
    s_waitcnt lgkmcnt(10)
    v_mfma_f32_32x32x16_bf16 v[128:143], v[80:83], v[112:115], v[128:143]
    ds_read_b128 v[72:75], v46 offset:0
    ds_read_b128 v[104:107], v50 offset:16384
    s_waitcnt lgkmcnt(10)
    v_mfma_f32_32x32x16_bf16 v[128:143], v[84:87], v[116:119], v[128:143]
    ds_read_b128 v[76:79], v47 offset:0
    ds_read_b128 v[108:111], v51 offset:16384
    s_waitcnt lgkmcnt(10)
    v_mfma_f32_32x32x16_bf16 v[128:143], v[88:91], v[120:123], v[128:143]
    ds_read_b128 v[80:83], v44 offset:16384
    ds_read_b128 v[112:115], v48 offset:20480
    s_waitcnt lgkmcnt(10)
    v_mfma_f32_32x32x16_bf16 v[128:143], v[92:95], v[124:127], v[128:143]
    ds_read_b128 v[84:87], v45 offset:16384
    ds_read_b128 v[116:119], v49 offset:20480
    s_waitcnt lgkmcnt(10)
    v_mfma_f32_32x32x16_bf16 v[128:143], v[64:67], v[96:99], v[128:143]
    ds_read_b128 v[88:91], v46 offset:16384
    ds_read_b128 v[120:123], v50 offset:20480
    s_waitcnt lgkmcnt(10)
    v_mfma_f32_32x32x16_bf16 v[128:143], v[68:71], v[100:103], v[128:143]
    ds_read_b128 v[92:95], v47 offset:16384
    ds_read_b128 v[124:127], v51 offset:20480
    s_waitcnt lgkmcnt(10)
    v_mfma_f32_32x32x16_bf16 v[128:143], v[72:75], v[104:107], v[128:143]
    s_waitcnt lgkmcnt(8)
    v_mfma_f32_32x32x16_bf16 v[128:143], v[76:79], v[108:111], v[128:143]
    s_waitcnt lgkmcnt(6)
    v_mfma_f32_32x32x16_bf16 v[128:143], v[80:83], v[112:115], v[128:143]
    s_waitcnt lgkmcnt(4)
    v_mfma_f32_32x32x16_bf16 v[128:143], v[84:87], v[116:119], v[128:143]
    s_waitcnt lgkmcnt(2)
    v_mfma_f32_32x32x16_bf16 v[128:143], v[88:91], v[120:123], v[128:143]
    s_waitcnt lgkmcnt(0)
    v_mfma_f32_32x32x16_bf16 v[128:143], v[92:95], v[124:127], v[128:143]
    s_barrier
    ds_read_b128 v[64:67], v44 offset:32768
    ds_read_b128 v[96:99], v48 offset:24576
    ds_read_b128 v[68:71], v45 offset:32768
    ds_read_b128 v[100:103], v49 offset:24576
    ds_read_b128 v[72:75], v46 offset:32768
    ds_read_b128 v[104:107], v50 offset:24576
    ds_read_b128 v[76:79], v47 offset:32768
    ds_read_b128 v[108:111], v51 offset:24576
    s_waitcnt lgkmcnt(6)
    v_mfma_f32_32x32x16_bf16 v[128:143], v[64:67], v[96:99], v[128:143]
    s_waitcnt lgkmcnt(4)
    v_mfma_f32_32x32x16_bf16 v[128:143], v[68:71], v[100:103], v[128:143]
    s_waitcnt lgkmcnt(2)
    v_mfma_f32_32x32x16_bf16 v[128:143], v[72:75], v[104:107], v[128:143]
    s_waitcnt lgkmcnt(0)
    v_mfma_f32_32x32x16_bf16 v[128:143], v[76:79], v[108:111], v[128:143]
    ds_read_b128 v[112:115], v48 offset:28672
    ds_read_b128 v[116:119], v49 offset:28672
    ds_read_b128 v[120:123], v50 offset:28672
    ds_read_b128 v[124:127], v51 offset:28672
    s_waitcnt lgkmcnt(0)
    s_barrier
    ds_read_b128 v[80:83], v44 offset:49152
    ds_read_b128 v[84:87], v45 offset:49152
    ds_read_b128 v[88:91], v46 offset:49152
    ds_read_b128 v[92:95], v47 offset:49152
    s_waitcnt lgkmcnt(3)
    v_mfma_f32_32x32x16_bf16 v[128:143], v[80:83], v[112:115], v[128:143]
    s_waitcnt lgkmcnt(2)
    v_mfma_f32_32x32x16_bf16 v[128:143], v[84:87], v[116:119], v[128:143]
    s_waitcnt lgkmcnt(1)
    v_mfma_f32_32x32x16_bf16 v[128:143], v[88:91], v[120:123], v[128:143]
    s_waitcnt lgkmcnt(0)
    v_mfma_f32_32x32x16_bf16 v[128:143], v[92:95], v[124:127], v[128:143]
    s_nop 11
    v_max3_f32 v54, v128, v129, v130
    v_max3_f32 v55, v131, v132, v133
    v_max3_f32 v54, v54, v134, v135
    v_max3_f32 v55, v55, v136, v137
    v_max3_f32 v54, v54, v138, v139
    v_max3_f32 v55, v55, v140, v141
    v_max3_f32 v54, v54, v142, v143
    v_max_f32 v54, v54, v55
    v_mov_b32 v55, v54
    s_nop 1
    v_permlane32_swap_b32 v54, v55
    v_max_f32 v54, v54, v55
    ds_write_b32 v52, v54
    s_waitcnt lgkmcnt(0)
    s_barrier
    ds_read_b128 v[56:59], v33
    s_waitcnt lgkmcnt(0)
    v_max3_f32 v54, v56, v57, v58
    v_max_f32 v62, v54, v59
    v_mov_b32 v60, v62
    v_mov_b32 v61, v62
    v_pk_add_f32 v[128:129], v[128:129], v[60:61] neg_lo:[0,1] neg_hi:[0,1]
    v_pk_add_f32 v[130:131], v[130:131], v[60:61] neg_lo:[0,1] neg_hi:[0,1]
    v_pk_add_f32 v[132:133], v[132:133], v[60:61] neg_lo:[0,1] neg_hi:[0,1]
    v_pk_add_f32 v[134:135], v[134:135], v[60:61] neg_lo:[0,1] neg_hi:[0,1]
    v_exp_f32 v128, v128
    v_exp_f32 v129, v129
    v_exp_f32 v130, v130
    v_exp_f32 v131, v131
    v_exp_f32 v132, v132
    v_exp_f32 v133, v133
    v_exp_f32 v134, v134
    v_exp_f32 v135, v135
    v_cvt_pk_bf16_f32 v64, v128, v129
    v_cvt_pk_bf16_f32 v65, v130, v131
    v_cvt_pk_bf16_f32 v66, v132, v133
    v_cvt_pk_bf16_f32 v67, v134, v135
    ds_write_b128 v53, v[64:67] offset:0
    v_pk_add_f32 v[136:137], v[136:137], v[60:61] neg_lo:[0,1] neg_hi:[0,1]
    v_pk_add_f32 v[138:139], v[138:139], v[60:61] neg_lo:[0,1] neg_hi:[0,1]
    v_pk_add_f32 v[140:141], v[140:141], v[60:61] neg_lo:[0,1] neg_hi:[0,1]
    v_pk_add_f32 v[142:143], v[142:143], v[60:61] neg_lo:[0,1] neg_hi:[0,1]
    v_exp_f32 v136, v136
    v_exp_f32 v137, v137
    v_exp_f32 v138, v138
    v_exp_f32 v139, v139
    v_exp_f32 v140, v140
    v_exp_f32 v141, v141
    v_exp_f32 v142, v142
    v_exp_f32 v143, v143
    v_cvt_pk_bf16_f32 v68, v136, v137
    v_cvt_pk_bf16_f32 v69, v138, v139
    v_cvt_pk_bf16_f32 v70, v140, v141
    v_cvt_pk_bf16_f32 v71, v142, v143
    ds_write_b128 v53, v[68:71] offset:1024
    v_pk_add_f32 v[128:129], v[128:129], v[130:131]
    v_pk_add_f32 v[132:133], v[132:133], v[134:135]
    v_pk_add_f32 v[136:137], v[136:137], v[138:139]
    v_pk_add_f32 v[140:141], v[140:141], v[142:143]
    v_pk_add_f32 v[128:129], v[128:129], v[132:133]
    v_pk_add_f32 v[136:137], v[136:137], v[140:141]
    v_pk_add_f32 v[128:129], v[128:129], v[136:137]
    v_add_f32 v54, v128, v129
    v_mov_b32 v55, v54
    s_nop 1
    v_permlane32_swap_b32 v54, v55
    v_add_f32 v54, v54, v55
    ds_write_b32 v52, v54 offset:512
    s_waitcnt lgkmcnt(0)
    s_branch L_barD
L_loader:
    v_lshlrev_b32 v251, 10, v5
    v_lshl_add_u32 v251, v4, 4, v251
    s_lshl_b32 s92, s3, 7
    v_add_u32 v251, s92, v251
    s_lshl_b32 s92, s26, 14
    v_add_u32 v56, s92, v251
    v_add_u32 v57, 8192, v56
    global_load_dwordx4 v[176:179], v56, s[74:75] nt
    global_load_dwordx4 v[180:183], v57, s[74:75] nt
    s_sub_u32 s92, s43, 16
    s_cmp_ge_u32 s92, 14
    s_cbranch_scc1 L_nw22
    s_xor_b32 s92, s23, 128
    s_lshl_b32 s92, s92, 14
    v_add_u32 v56, s92, v251
    v_add_u32 v57, 8192, v56
    global_load_dwordx4 v[184:187], v56, s[82:83] nt
    global_load_dwordx4 v[188:191], v57, s[82:83] nt
L_nw22:
    s_add_u32 m0, s21, 1024
    s_add_u32 s92, s20, 8192
    buffer_load_dwordx4 v25, s[8:11], s92 offen nt lds
    s_add_u32 m0, s21, 2048
    s_add_u32 s92, s20, 16384
    buffer_load_dwordx4 v24, s[8:11], s92 offen nt lds
    s_add_u32 m0, s21, 3072
    s_add_u32 s92, s20, 24576
    buffer_load_dwordx4 v25, s[8:11], s92 offen nt lds
    s_add_u32 m0, s21, 16384
    s_add_u32 s92, s20, 128
    buffer_load_dwordx4 v24, s[8:11], s92 offen nt lds
    s_waitcnt vmcnt(4)
    s_add_u32 m0, s21, 17408
    s_add_u32 s92, s20, 8320
    buffer_load_dwordx4 v25, s[8:11], s92 offen nt lds
    s_waitcnt vmcnt(4)
    s_add_u32 m0, s21, 18432
    s_add_u32 s92, s20, 16512
    buffer_load_dwordx4 v24, s[8:11], s92 offen nt lds
    s_waitcnt vmcnt(4)
    s_add_u32 m0, s21, 19456
    s_add_u32 s92, s20, 24704
    buffer_load_dwordx4 v25, s[8:11], s92 offen nt lds
    s_waitcnt vmcnt(4)
    s_add_u32 m0, s21, 32768
    s_add_u32 s92, s20, 256
    buffer_load_dwordx4 v24, s[8:11], s92 offen nt lds
    s_waitcnt vmcnt(4)
    s_add_u32 m0, s21, 33792
    s_add_u32 s92, s20, 8448
    buffer_load_dwordx4 v25, s[8:11], s92 offen nt lds
    s_waitcnt vmcnt(4)
    s_add_u32 m0, s21, 34816
    s_add_u32 s92, s20, 16640
    buffer_load_dwordx4 v24, s[8:11], s92 offen nt lds
    s_waitcnt vmcnt(4)
    s_add_u32 m0, s21, 35840
    s_add_u32 s92, s20, 24832
    buffer_load_dwordx4 v25, s[8:11], s92 offen nt lds
    s_waitcnt vmcnt(4)
    s_add_u32 m0, s21, 49152
    s_add_u32 s92, s20, 384
    buffer_load_dwordx4 v24, s[8:11], s92 offen nt lds
    s_waitcnt vmcnt(4)
    s_add_u32 m0, s21, 50176
    s_add_u32 s92, s20, 8576
    buffer_load_dwordx4 v25, s[8:11], s92 offen nt lds
    s_waitcnt vmcnt(4)
    s_add_u32 m0, s21, 51200
    s_add_u32 s92, s20, 16768
    buffer_load_dwordx4 v24, s[8:11], s92 offen nt lds
    s_waitcnt vmcnt(4)
    s_add_u32 m0, s21, 52224
    s_add_u32 s92, s20, 24960
    buffer_load_dwordx4 v25, s[8:11], s92 offen nt lds
    s_waitcnt vmcnt(4)
    s_add_u32 m0, s21, 65536
    s_add_u32 s92, s20, 512
    buffer_load_dwordx4 v24, s[8:11], s92 offen nt lds
    s_waitcnt vmcnt(4)
    s_add_u32 m0, s21, 66560
    s_add_u32 s92, s20, 8704
    buffer_load_dwordx4 v25, s[8:11], s92 offen nt lds
    s_waitcnt vmcnt(4)
    s_add_u32 m0, s21, 67584
    s_add_u32 s92, s20, 16896
    buffer_load_dwordx4 v24, s[8:11], s92 offen nt lds
    s_waitcnt vmcnt(4)
    s_add_u32 m0, s21, 68608
    s_add_u32 s92, s20, 25088
    buffer_load_dwordx4 v25, s[8:11], s92 offen nt lds
    s_waitcnt vmcnt(4)
    s_add_u32 m0, s21, 81920
    s_add_u32 s92, s20, 640
    buffer_load_dwordx4 v24, s[8:11], s92 offen nt lds
    s_waitcnt vmcnt(4)
    s_add_u32 m0, s21, 82944
    s_add_u32 s92, s20, 8832
    buffer_load_dwordx4 v25, s[8:11], s92 offen nt lds
    s_waitcnt vmcnt(4)
    s_add_u32 m0, s21, 83968
    s_add_u32 s92, s20, 17024
    buffer_load_dwordx4 v24, s[8:11], s92 offen nt lds
    s_waitcnt vmcnt(4)
    s_add_u32 m0, s21, 84992
    s_add_u32 s92, s20, 25216
    buffer_load_dwordx4 v25, s[8:11], s92 offen nt lds
    s_add_u32 m0, s24, 0
    s_add_u32 s92, s25, 0
    buffer_load_dwordx4 v27, s[12:15], s92 offen sc1 lds
    s_add_u32 m0, s24, 4096
    s_add_u32 s92, s25, 128
    buffer_load_dwordx4 v27, s[12:15], s92 offen sc1 lds
    s_add_u32 m0, s24, 8192
    s_add_u32 s92, s25, 256
    buffer_load_dwordx4 v27, s[12:15], s92 offen sc1 lds
    s_add_u32 m0, s24, 12288
    s_add_u32 s92, s25, 384
    buffer_load_dwordx4 v27, s[12:15], s92 offen sc1 lds
    s_add_u32 m0, s24, 16384
    s_add_u32 s92, s25, 512
    buffer_load_dwordx4 v27, s[12:15], s92 offen sc1 lds
    s_add_u32 m0, s24, 20480
    s_add_u32 s92, s25, 640
    buffer_load_dwordx4 v27, s[12:15], s92 offen sc1 lds
    s_add_u32 m0, s24, 24576
    s_add_u32 s92, s25, 768
    buffer_load_dwordx4 v27, s[12:15], s92 offen sc1 lds
    s_add_u32 m0, s24, 28672
    s_add_u32 s92, s25, 896
    buffer_load_dwordx4 v27, s[12:15], s92 offen sc1 lds
    s_waitcnt vmcnt(10)
    s_add_u32 m0, s21, 98304
    s_add_u32 s92, s20, 768
    buffer_load_dwordx4 v24, s[8:11], s92 offen nt lds
    s_waitcnt vmcnt(10)
    s_add_u32 m0, s21, 99328
    s_add_u32 s92, s20, 8960
    buffer_load_dwordx4 v25, s[8:11], s92 offen nt lds
    s_waitcnt vmcnt(10)
    s_add_u32 m0, s21, 100352
    s_add_u32 s92, s20, 17152
    buffer_load_dwordx4 v24, s[8:11], s92 offen nt lds
    s_waitcnt vmcnt(10)
    s_add_u32 m0, s21, 101376
    s_add_u32 s92, s20, 25344
    buffer_load_dwordx4 v25, s[8:11], s92 offen nt lds
    s_waitcnt vmcnt(10)
    s_add_u32 m0, s21, 114688
    s_add_u32 s92, s20, 896
    buffer_load_dwordx4 v24, s[8:11], s92 offen nt lds
    s_waitcnt vmcnt(10)
    s_add_u32 m0, s21, 115712
    s_add_u32 s92, s20, 9088
    buffer_load_dwordx4 v25, s[8:11], s92 offen nt lds
    s_waitcnt vmcnt(10)
    s_add_u32 m0, s21, 116736
    s_add_u32 s92, s20, 17280
    buffer_load_dwordx4 v24, s[8:11], s92 offen nt lds
    s_waitcnt vmcnt(10)
    s_add_u32 m0, s21, 117760
    s_add_u32 s92, s20, 25472
    buffer_load_dwordx4 v25, s[8:11], s92 offen nt lds
    s_cmp_eq_u32 s31, 0
    s_cbranch_scc1 L_nohx2
    buffer_load_dwordx4 v[160:163], v174, s[12:15], 0 offen sc1
    global_load_ushort v164, v175, s[80:81]
L_nohx2:
    s_mov_b32 s28, 0
    s_cmp_eq_u32 s31, 0
    s_cbranch_scc0 L_a16
    s_waitcnt vmcnt(8)
L_a16:
    s_waitcnt vmcnt(10)
L_gchk:
    ds_read_b128 v[64:67], v40 offset:0
    ds_read_b128 v[68:71], v40 offset:4096
    ds_read_b128 v[72:75], v40 offset:8192
    ds_read_b128 v[76:79], v40 offset:12288
    ds_read_b128 v[80:83], v40 offset:16384
    ds_read_b128 v[84:87], v40 offset:20480
    ds_read_b128 v[88:91], v40 offset:24576
    ds_read_b128 v[92:95], v40 offset:28672
    v_mov_b32 v56, 0
    s_waitcnt lgkmcnt(7)
    v_bitop3_b32 v56, v64, v52, v56 bitop3:0xbe
    v_bitop3_b32 v56, v65, v53, v56 bitop3:0xbe
    v_bitop3_b32 v56, v66, v54, v56 bitop3:0xbe
    v_bitop3_b32 v56, v67, v55, v56 bitop3:0xbe
    s_waitcnt lgkmcnt(6)
    v_bitop3_b32 v56, v68, v52, v56 bitop3:0xbe
    v_bitop3_b32 v56, v69, v53, v56 bitop3:0xbe
    v_bitop3_b32 v56, v70, v54, v56 bitop3:0xbe
    v_bitop3_b32 v56, v71, v55, v56 bitop3:0xbe
    s_waitcnt lgkmcnt(5)
    v_bitop3_b32 v56, v72, v52, v56 bitop3:0xbe
    v_bitop3_b32 v56, v73, v53, v56 bitop3:0xbe
    v_bitop3_b32 v56, v74, v54, v56 bitop3:0xbe
    v_bitop3_b32 v56, v75, v55, v56 bitop3:0xbe
    s_waitcnt lgkmcnt(4)
    v_bitop3_b32 v56, v76, v52, v56 bitop3:0xbe
    v_bitop3_b32 v56, v77, v53, v56 bitop3:0xbe
    v_bitop3_b32 v56, v78, v54, v56 bitop3:0xbe
    v_bitop3_b32 v56, v79, v55, v56 bitop3:0xbe
    s_waitcnt lgkmcnt(3)
    v_bitop3_b32 v56, v80, v52, v56 bitop3:0xbe
    v_bitop3_b32 v56, v81, v53, v56 bitop3:0xbe
    v_bitop3_b32 v56, v82, v54, v56 bitop3:0xbe
    v_bitop3_b32 v56, v83, v55, v56 bitop3:0xbe
    s_waitcnt lgkmcnt(2)
    v_bitop3_b32 v56, v84, v52, v56 bitop3:0xbe
    v_bitop3_b32 v56, v85, v53, v56 bitop3:0xbe
    v_bitop3_b32 v56, v86, v54, v56 bitop3:0xbe
    v_bitop3_b32 v56, v87, v55, v56 bitop3:0xbe
    s_waitcnt lgkmcnt(1)
    v_bitop3_b32 v56, v88, v52, v56 bitop3:0xbe
    v_bitop3_b32 v56, v89, v53, v56 bitop3:0xbe
    v_bitop3_b32 v56, v90, v54, v56 bitop3:0xbe
    v_bitop3_b32 v56, v91, v55, v56 bitop3:0xbe
    s_waitcnt lgkmcnt(0)
    v_bitop3_b32 v56, v92, v52, v56 bitop3:0xbe
    v_bitop3_b32 v56, v93, v53, v56 bitop3:0xbe
    v_bitop3_b32 v56, v94, v54, v56 bitop3:0xbe
    v_bitop3_b32 v56, v95, v55, v56 bitop3:0xbe
    v_and_b32 v56, v14, v56
    v_cmp_ne_u32 vcc, 0, v56
    s_nop 0
    s_cbranch_vccz L_gok
    s_add_u32 s28, s28, 1
    s_cmp_gt_u32 s28, 1048576
    s_cbranch_scc1 L_gfail
    s_add_u32 m0, s24, 0
    s_add_u32 s92, s25, 0
    buffer_load_dwordx4 v27, s[12:15], s92 offen sc1 lds
    s_add_u32 m0, s24, 4096
    s_add_u32 s92, s25, 128
    buffer_load_dwordx4 v27, s[12:15], s92 offen sc1 lds
    s_add_u32 m0, s24, 8192
    s_add_u32 s92, s25, 256
    buffer_load_dwordx4 v27, s[12:15], s92 offen sc1 lds
    s_add_u32 m0, s24, 12288
    s_add_u32 s92, s25, 384
    buffer_load_dwordx4 v27, s[12:15], s92 offen sc1 lds
    s_add_u32 m0, s24, 16384
    s_add_u32 s92, s25, 512
    buffer_load_dwordx4 v27, s[12:15], s92 offen sc1 lds
    s_add_u32 m0, s24, 20480
    s_add_u32 s92, s25, 640
    buffer_load_dwordx4 v27, s[12:15], s92 offen sc1 lds
    s_add_u32 m0, s24, 24576
    s_add_u32 s92, s25, 768
    buffer_load_dwordx4 v27, s[12:15], s92 offen sc1 lds
    s_add_u32 m0, s24, 28672
    s_add_u32 s92, s25, 896
    buffer_load_dwordx4 v27, s[12:15], s92 offen sc1 lds
    s_waitcnt vmcnt(0)
    s_branch L_gchk
L_gfail:
    v_mov_b32 v60, 4
    v_mov_b32 v61, 1
    s_mov_b64 exec, 1
    global_atomic_add v60, v61, s[88:89]
    s_mov_b64 exec, -1
L_gok:
    s_barrier
    s_cmp_eq_u32 s31, 0
    s_cbranch_scc0 L_a26
    s_waitcnt vmcnt(4)
L_a26:
    s_waitcnt vmcnt(6)
    s_barrier
    s_waitcnt vmcnt(0)
    s_barrier
    s_cmp_eq_u32 s31, 0
    s_cbranch_scc1 L_noh
    s_mov_b32 s28, 0
L_hx:
    v_xor_b32 v56, s37, v160
    v_bitop3_b32 v56, v161, s38, v56 bitop3:0xbe
    v_bitop3_b32 v56, v162, s39, v56 bitop3:0xbe
    v_bitop3_b32 v56, v163, s40, v56 bitop3:0xbe
    v_and_b32 v56, v15, v56
    v_cmp_ne_u32 vcc, 0, v56
    s_nop 0
    s_cbranch_vccz L_hxok
    s_add_u32 s28, s28, 1
    s_cmp_gt_u32 s28, 1048576
    s_cbranch_scc1 L_hxfail
    buffer_load_dwordx4 v[160:163], v174, s[12:15], 0 offen sc1
    s_waitcnt vmcnt(0)
    s_branch L_hx
L_hxfail:
    v_mov_b32 v60, 32
    v_mov_b32 v61, 1
    s_mov_b64 exec, 1
    global_atomic_add v60, v61, s[88:89]
    s_mov_b64 exec, -1
L_hxok:
    v_add_f32_dpp v160, v160, v160 row_ror:8 row_mask:0xf bank_mask:0xf
    v_add_f32_dpp v161, v161, v161 row_ror:8 row_mask:0xf bank_mask:0xf
    v_add_f32_dpp v162, v162, v162 row_ror:8 row_mask:0xf bank_mask:0xf
    v_add_f32_dpp v163, v163, v163 row_ror:8 row_mask:0xf bank_mask:0xf
    v_lshlrev_b32 v56, 4, v4
    v_lshl_add_u32 v56, v3, 7, v56
    v_add_u32 v56, 136832, v56
    v_lshlrev_b32 v57, 2, v7
    v_add_u32 v57, 136832, v57
    s_mov_b32 exec_lo, 0xff00ff
    s_mov_b32 exec_hi, 0xff00ff
    ds_write_b128 v56, v[160:163]
    s_mov_b64 exec, -1
    v_lshlrev_b32 v164, 16, v164
    v_lshlrev_b32 v58, 1, v7
    v_add_u32 v58, 137472, v58
    s_waitcnt lgkmcnt(0)
    ds_read2_b32 v[128:129], v57 offset1:32
    ds_read2_b32 v[130:131], v57 offset0:64 offset1:96
    s_mov_b32 s92, 0x3d372713
    s_waitcnt lgkmcnt(0)
    v_add_f32 v128, v128, v129
    v_add_f32 v130, v130, v131
    v_add_f32 v128, v128, v130
    v_cvt_pk_bf16_f32 v128, v128, v128
    v_and_b32 v128, 0xffff0000, v128
    v_add_f32 v128, v128, v164
    v_cvt_pk_bf16_f32 v128, v128, v128
    v_and_b32 v128, 0xffff0000, v128
    v_mul_f32 v129, v128, v128
    v_fma_f32 v129, v129, s92, 1.0
    v_mul_f32 v129, v129, v128
    v_mul_f32 v129, 0xc0135761, v129
    v_exp_f32 v129, v129
    s_nop 0
    v_add_f32 v129, 1.0, v129
    v_rcp_f32 v129, v129
    s_nop 0
    v_mul_f32 v128, v128, v129
    v_cvt_pk_bf16_f32 v128, v128, v128
    ds_write_b16 v58, v128
    s_waitcnt lgkmcnt(0)
L_noh:
    s_barrier
L_barD:
    s_barrier
    s_setprio 1
    ds_read_b128 v[64:67], v32 offset:0
    ds_read_b64_tr_b16 v[96:97], v28 offset:0
    ds_read_b64_tr_b16 v[98:99], v29 offset:0
    ds_read_b128 v[68:71], v32 offset:1024
    ds_read_b64_tr_b16 v[100:101], v28 offset:2048
    ds_read_b64_tr_b16 v[102:103], v29 offset:2048
    ds_read_b128 v[72:75], v32 offset:2048
    ds_read_b64_tr_b16 v[104:105], v28 offset:4096
    ds_read_b64_tr_b16 v[106:107], v29 offset:4096
    ds_read_b128 v[76:79], v32 offset:3072
    ds_read_b64_tr_b16 v[108:109], v28 offset:6144
    ds_read_b64_tr_b16 v[110:111], v29 offset:6144
    s_waitcnt lgkmcnt(9)
    v_mfma_f32_32x32x16_bf16 v[128:143], v[96:99], v[64:67], 0
    ds_read_b128 v[80:83], v32 offset:4096
    ds_read_b64_tr_b16 v[112:113], v28 offset:8192
    ds_read_b64_tr_b16 v[114:115], v29 offset:8192
    s_cmp_lg_u32 s3, 1
    s_cbranch_scc1 L_ai3
    s_mov_b32 s96, 1
    s_atomic_add s96, s[90:91], s7 glc
L_ai3:
    s_waitcnt lgkmcnt(9)
    v_mfma_f32_32x32x16_bf16 v[128:143], v[100:103], v[68:71], v[128:143]
    ds_read_b128 v[84:87], v32 offset:5120
    ds_read_b64_tr_b16 v[116:117], v28 offset:10240
    ds_read_b64_tr_b16 v[118:119], v29 offset:10240
    s_waitcnt lgkmcnt(9)
    v_mfma_f32_32x32x16_bf16 v[128:143], v[104:107], v[72:75], v[128:143]
    ds_read_b128 v[88:91], v32 offset:6144
    ds_read_b64_tr_b16 v[120:121], v28 offset:12288
    ds_read_b64_tr_b16 v[122:123], v29 offset:12288
    s_waitcnt lgkmcnt(9)
    v_mfma_f32_32x32x16_bf16 v[128:143], v[108:111], v[76:79], v[128:143]
    ds_read_b128 v[92:95], v32 offset:7168
    ds_read_b64_tr_b16 v[124:125], v28 offset:14336
    ds_read_b64_tr_b16 v[126:127], v29 offset:14336
    s_waitcnt lgkmcnt(9)
    v_mfma_f32_32x32x16_bf16 v[128:143], v[112:115], v[80:83], v[128:143]
    ds_read_b64_tr_b16 v[96:97], v30 offset:0
    ds_read_b64_tr_b16 v[98:99], v31 offset:0
    ds_read_b128 v[52:55], v33 offset:512
    s_waitcnt lgkmcnt(9)
    v_mfma_f32_32x32x16_bf16 v[128:143], v[116:119], v[84:87], v[128:143]
    ds_read_b64_tr_b16 v[100:101], v30 offset:2048
    ds_read_b64_tr_b16 v[102:103], v31 offset:2048
    s_waitcnt lgkmcnt(8)
    v_mfma_f32_32x32x16_bf16 v[128:143], v[120:123], v[88:91], v[128:143]
    ds_read_b64_tr_b16 v[104:105], v30 offset:4096
    ds_read_b64_tr_b16 v[106:107], v31 offset:4096
    s_waitcnt lgkmcnt(7)
    v_mfma_f32_32x32x16_bf16 v[128:143], v[124:127], v[92:95], v[128:143]
    ds_read_b64_tr_b16 v[108:109], v30 offset:6144
    ds_read_b64_tr_b16 v[110:111], v31 offset:6144
    s_waitcnt lgkmcnt(7)
    v_mfma_f32_32x32x16_bf16 v[144:159], v[96:99], v[64:67], 0
    ds_read_b64_tr_b16 v[112:113], v30 offset:8192
    ds_read_b64_tr_b16 v[114:115], v31 offset:8192
    s_waitcnt lgkmcnt(6)
    v_mfma_f32_32x32x16_bf16 v[144:159], v[100:103], v[68:71], v[144:159]
    ds_read_b64_tr_b16 v[116:117], v30 offset:10240
    ds_read_b64_tr_b16 v[118:119], v31 offset:10240
    s_cmp_lg_u32 s3, 0
    s_cbranch_scc1 L_nolse
    v_add_f32 v52, v52, v53
    v_add_f32 v54, v54, v55
    v_mov_b32 v56, v62
    v_mov_b32 v58, s36
    v_add_f32 v57, v52, v54
    v_lshlrev_b32 v52, 4, v7
    s_lshl_b32 s92, s34, 9
    s_add_u32 s92, s92, 3145728
    s_mov_b32 exec_lo, 0xffffffff
    s_mov_b32 exec_hi, 0x0
    buffer_store_dwordx4 v[56:59], v52, s[12:15], s92 offen sc1
    s_mov_b64 exec, -1
L_nolse:
    s_waitcnt lgkmcnt(6)
    v_mfma_f32_32x32x16_bf16 v[144:159], v[104:107], v[72:75], v[144:159]
    ds_read_b64_tr_b16 v[120:121], v30 offset:12288
    ds_read_b64_tr_b16 v[122:123], v31 offset:12288
    s_mov_b32 exec_lo, 0xf
    s_mov_b32 exec_hi, 0x0
    buffer_load_dword v63, v18, s[12:15], s27 offen sc1
    s_mov_b64 exec, -1
    s_waitcnt lgkmcnt(6)
    v_mfma_f32_32x32x16_bf16 v[144:159], v[108:111], v[76:79], v[144:159]
    ds_read_b64_tr_b16 v[124:125], v30 offset:14336
    ds_read_b64_tr_b16 v[126:127], v31 offset:14336
    s_waitcnt lgkmcnt(6)
    v_mfma_f32_32x32x16_bf16 v[144:159], v[112:115], v[80:83], v[144:159]
    s_waitcnt lgkmcnt(4)
    v_mfma_f32_32x32x16_bf16 v[144:159], v[116:119], v[84:87], v[144:159]
    v_cvt_pk_bf16_f32 v192, v128, v129
    v_cvt_pk_bf16_f32 v193, v130, v131
    v_cvt_pk_bf16_f32 v194, v132, v133
    v_cvt_pk_bf16_f32 v195, v134, v135
    ds_write_b128 v34, v[192:195]
    s_waitcnt lgkmcnt(3)
    v_mfma_f32_32x32x16_bf16 v[144:159], v[120:123], v[88:91], v[144:159]
    v_cvt_pk_bf16_f32 v196, v136, v137
    v_cvt_pk_bf16_f32 v197, v138, v139
    v_cvt_pk_bf16_f32 v198, v140, v141
    v_cvt_pk_bf16_f32 v199, v142, v143
    ds_write_b128 v35, v[196:199]
    s_waitcnt lgkmcnt(2)
    v_mfma_f32_32x32x16_bf16 v[144:159], v[124:127], v[92:95], v[144:159]
    s_setprio 0
    s_nop 10
    v_cvt_pk_bf16_f32 v200, v144, v145
    v_cvt_pk_bf16_f32 v201, v146, v147
    v_cvt_pk_bf16_f32 v202, v148, v149
    v_cvt_pk_bf16_f32 v203, v150, v151
    ds_write_b128 v36, v[200:203]
    v_cvt_pk_bf16_f32 v204, v152, v153
    v_cvt_pk_bf16_f32 v205, v154, v155
    v_cvt_pk_bf16_f32 v206, v156, v157
    v_cvt_pk_bf16_f32 v207, v158, v159
    ds_write_b128 v37, v[204:207]
    s_waitcnt lgkmcnt(0)
    ds_read_b128 v[80:83], v38 offset:0
    ds_read_b128 v[84:87], v38 offset:1024
    ds_read_b128 v[88:91], v38 offset:2048
    ds_read_b128 v[92:95], v38 offset:3072
    s_waitcnt lgkmcnt(3)
    v_bfi_b32 v80, v14, v10, v80
    v_bfi_b32 v81, v14, v11, v81
    v_bfi_b32 v82, v14, v12, v82
    v_bfi_b32 v83, v14, v13, v83
    buffer_store_dwordx4 v[80:83], v39, s[12:15], s29 offen sc1
    s_add_u32 s29, s29, 2097152
    s_waitcnt lgkmcnt(2)
    v_bfi_b32 v84, v14, v10, v84
    v_bfi_b32 v85, v14, v11, v85
    v_bfi_b32 v86, v14, v12, v86
    v_bfi_b32 v87, v14, v13, v87
    buffer_store_dwordx4 v[84:87], v39, s[12:15], s29 offen sc1
    s_add_u32 s29, s29, 2097152
    s_waitcnt lgkmcnt(1)
    v_bfi_b32 v88, v14, v10, v88
    v_bfi_b32 v89, v14, v11, v89
    v_bfi_b32 v90, v14, v12, v90
    v_bfi_b32 v91, v14, v13, v91
    buffer_store_dwordx4 v[88:91], v39, s[12:15], s29 offen sc1
    s_add_u32 s29, s29, 2097152
    s_waitcnt lgkmcnt(0)
    v_bfi_b32 v92, v14, v10, v92
    v_bfi_b32 v93, v14, v11, v93
    v_bfi_b32 v94, v14, v12, v94
    v_bfi_b32 v95, v14, v13, v95
    buffer_store_dwordx4 v[92:95], v39, s[12:15], s29 offen sc1
    s_cmp_lg_u32 s3, 1
    s_cbranch_scc1 L_ac4
    s_waitcnt lgkmcnt(0)
    s_sub_u32 s96, s96, s41
    s_cmp_lg_u32 s96, 31
    s_cbranch_scc1 L_ac4
    s_add_u32 s94, s7, 4096
    v_mov_b32 v251, s36
    s_mov_b64 exec, 1
    buffer_store_dword v251, v9, s[12:15], s94 offen sc1
    s_mov_b64 exec, -1
L_ac4:
    s_mov_b32 s97, 15
    s_waitcnt vmcnt(4)
    s_barrier
    v_cmp_eq_u32 vcc, s36, v63
    s_nop 0
    s_and_b32 s95, vcc_lo, s97
    s_bitcmp1_b32 s95, 0
    s_cbranch_scc0 L_hk5
    s_add_u32 s92, s68, 0
    buffer_load_dwordx3 v[144:146], v250, s[12:15], s92 offen sc1
    buffer_load_dwordx4 v[64:67], v6, s[12:15], s69 offen offset:0 sc1
L_hk5:
    s_bitcmp1_b32 s95, 1
    s_cbranch_scc0 L_hk6
    s_add_u32 s92, s68, 4096
    buffer_load_dwordx3 v[148:150], v250, s[12:15], s92 offen sc1
    buffer_load_dwordx4 v[68:71], v6, s[12:15], s69 offen offset:1024 sc1
L_hk6:
    s_bitcmp1_b32 s95, 2
    s_cbranch_scc0 L_hk7
    s_add_u32 s92, s68, 8192
    buffer_load_dwordx3 v[152:154], v250, s[12:15], s92 offen sc1
    buffer_load_dwordx4 v[72:75], v6, s[12:15], s69 offen offset:2048 sc1
L_hk7:
    s_bitcmp1_b32 s95, 3
    s_cbranch_scc0 L_hk8
    s_add_u32 s92, s68, 12288
    buffer_load_dwordx3 v[156:158], v250, s[12:15], s92 offen sc1
    buffer_load_dwordx4 v[76:79], v6, s[12:15], s69 offen offset:3072 sc1
L_hk8:
    s_andn2_b32 s97, s97, s95
L_late:
    s_sub_u32 s92, s3, 1
    s_cmp_ge_u32 s92, 2
    s_cbranch_scc1 L_nowv
    s_lshl_b32 s92, s92, 13
    s_add_u32 s92, s92, 147456
    v_add_u32 v56, s92, v6
    ds_write_b128 v56, v[208:211] offset:0
    ds_write_b128 v56, v[212:215] offset:1024
    ds_write_b128 v56, v[216:219] offset:2048
    ds_write_b128 v56, v[220:223] offset:3072
    ds_write_b128 v56, v[224:227] offset:4096
    ds_write_b128 v56, v[228:231] offset:5120
    ds_write_b128 v56, v[232:235] offset:6144
    ds_write_b128 v56, v[236:239] offset:7168
L_nowv:
    s_lshl_b32 s92, s3, 14
    s_add_u32 s92, s92, 4096
    v_add_u32 v57, s92, v6
    ds_write_b128 v57, v[176:179]
    ds_write_b128 v57, v[180:183] offset:1024
    ds_write_b128 v57, v[184:187] offset:4096
    ds_write_b128 v57, v[188:191] offset:5120
    s_cmp_eq_u32 s97, 0
    s_cselect_b32 s24, 0, 0
    s_sub_u32 s92, s43, 16
    s_cmp_ge_u32 s92, 14
    s_cbranch_scc1 L_noy1
    ds_read_b64 v[110:111], v249
    ds_read_b64_tr_b16 v[176:177], v243 offset:4096
    ds_read_b64_tr_b16 v[178:179], v243 offset:4128
    ds_read_b64_tr_b16 v[180:181], v243 offset:4160
    ds_read_b64_tr_b16 v[182:183], v243 offset:4192
    v_cmp_gt_u32 vcc, 2, v2
    s_waitcnt lgkmcnt(4)
    s_nop 0
    v_cndmask_b32 v110, 0, v110, vcc
    v_cndmask_b32 v111, 0, v111, vcc
    s_cmp_eq_u32 s97, 0
    s_cselect_b32 s24, 2, 0
    s_waitcnt lgkmcnt(0)
    v_mfma_f32_16x16x16_bf16 v[112:115], v[110:111], v[176:177], 0
    v_mfma_f32_16x16x16_bf16 v[116:119], v[110:111], v[178:179], 0
    v_mfma_f32_16x16x16_bf16 v[120:123], v[110:111], v[180:181], 0
    v_mfma_f32_16x16x16_bf16 v[124:127], v[110:111], v[182:183], 0
    s_nop 4
    v_add_f32 v112, v112, v114
    v_add_f32 v113, v113, v115
    v_add_f32 v116, v116, v118
    v_add_f32 v117, v117, v119
    v_add_f32 v120, v120, v122
    v_add_f32 v121, v121, v123
    v_add_f32 v124, v124, v126
    v_add_f32 v125, v125, v127
    v_permlane32_swap_b32 v112, v113
    v_permlane32_swap_b32 v116, v117
    v_permlane32_swap_b32 v120, v121
    v_permlane32_swap_b32 v124, v125
    v_add_f32 v112, v112, v113
    v_add_f32 v116, v116, v117
    v_add_f32 v120, v120, v121
    v_add_f32 v124, v124, v125
    v_permlane16_swap_b32 v112, v116
    s_nop 0
    v_permlane16_swap_b32 v120, v124
    v_add_f32 v112, v112, v116
    v_add_f32 v113, v120, v124
    v_bfi_b32 v112, v15, v16, v112
    v_bfi_b32 v113, v15, v16, v113
    buffer_store_dword v112, v247, s[12:15], s67 offen sc1
    buffer_store_dword v113, v247, s[12:15], s67 offen offset:128 sc1
L_noy1:
    ds_read_b64_tr_b16 v[184:185], v243
    ds_read_b64_tr_b16 v[186:187], v243 offset:32
    ds_read_b64_tr_b16 v[188:189], v243 offset:64
    ds_read_b64_tr_b16 v[190:191], v243 offset:96
    s_mov_b32 s29, 0
    s_mov_b32 s28, 0
    s_cmp_eq_u32 s97, 0
    s_cbranch_scc1 L_hpx
    s_mov_b64 exec, 1
L_hp:
    buffer_load_dword v63, v9, s[12:15], s27 offen sc1
    s_add_u32 s28, s28, 1
    s_cmp_gt_u32 s28, 1048576
    s_cbranch_scc1 L_hpy
    s_waitcnt vmcnt(0)
    v_cmp_ne_u32 vcc, s36, v63
    s_nop 0
    s_cbranch_vccnz L_hp
L_hpy:
    s_mov_b64 exec, -1
    s_add_u32 s92, s68, 0
    buffer_load_dwordx3 v[144:146], v250, s[12:15], s92 offen sc1
    buffer_load_dwordx4 v[64:67], v6, s[12:15], s69 offen offset:0 sc1
    s_add_u32 s92, s68, 4096
    buffer_load_dwordx3 v[148:150], v250, s[12:15], s92 offen sc1
    buffer_load_dwordx4 v[68:71], v6, s[12:15], s69 offen offset:1024 sc1
    s_add_u32 s92, s68, 8192
    buffer_load_dwordx3 v[152:154], v250, s[12:15], s92 offen sc1
    buffer_load_dwordx4 v[72:75], v6, s[12:15], s69 offen offset:2048 sc1
    s_add_u32 s92, s68, 12288
    buffer_load_dwordx3 v[156:158], v250, s[12:15], s92 offen sc1
    buffer_load_dwordx4 v[76:79], v6, s[12:15], s69 offen offset:3072 sc1
L_hpx:
    s_cmp_eq_u32 s24, 6
    s_cbranch_scc1 L_hw6
    s_cmp_eq_u32 s24, 4
    s_cbranch_scc1 L_hw4
    s_cmp_eq_u32 s24, 2
    s_cbranch_scc1 L_hw2
    s_waitcnt vmcnt(0)
L_hw2:
    s_waitcnt vmcnt(2)
L_hw4:
    s_waitcnt vmcnt(4)
L_hw6:
    s_waitcnt vmcnt(6)
L_h2:
    v_max_f32 v40, v144, v148
    v_max_f32 v42, v152, v156
    v_xor_b32 v37, s36, v146
    v_bitop3_b32 v37, v150, s36, v37 bitop3:0xbe
    v_max_f32_dpp v40, v40, v40 row_ror:8 row_mask:0xf bank_mask:0xf
    v_max_f32_dpp v42, v42, v42 row_ror:8 row_mask:0xf bank_mask:0xf
    v_mov_b32 v44, v40
    v_mov_b32 v45, v42
    s_nop 0
    v_permlane16_swap_b32 v40, v44
    v_permlane16_swap_b32 v42, v45
    v_max_f32 v40, v40, v44
    v_max_f32 v42, v42, v45
    v_mov_b32 v44, v40
    v_mov_b32 v45, v42
    s_nop 0
    v_permlane32_swap_b32 v40, v44
    v_permlane32_swap_b32 v42, v45
    v_max_f32 v40, v40, v44
    v_max_f32 v42, v42, v45
    v_sub_f32 v52, v144, v40
    v_sub_f32 v53, v148, v40
    v_sub_f32 v54, v152, v42
    v_sub_f32 v55, v156, v42
    v_exp_f32 v52, v52
    v_exp_f32 v53, v53
    v_exp_f32 v54, v54
    v_exp_f32 v55, v55
    v_bitop3_b32 v37, v154, s36, v37 bitop3:0xbe
    v_bitop3_b32 v37, v158, s36, v37 bitop3:0xbe
    v_cvt_pk_bf16_f32 v52, v52, 0
    v_cvt_pk_bf16_f32 v53, v53, 0
    v_cvt_pk_bf16_f32 v54, v54, 0
    v_cvt_pk_bf16_f32 v55, v55, 0
    v_mul_u32_u24 v80, v52, v20
    v_mul_u32_u24 v81, v52, v21
    v_mul_u32_u24 v82, v52, v22
    v_mul_u32_u24 v83, v52, v23
    v_mul_u32_u24 v84, v53, v20
    v_mul_u32_u24 v85, v53, v21
    v_mul_u32_u24 v86, v53, v22
    v_mul_u32_u24 v87, v53, v23
    v_mul_u32_u24 v88, v54, v20
    v_mul_u32_u24 v89, v54, v21
    v_mul_u32_u24 v90, v54, v22
    v_mul_u32_u24 v91, v54, v23
    v_mul_u32_u24 v92, v55, v20
    v_mul_u32_u24 v93, v55, v21
    v_mul_u32_u24 v94, v55, v22
    v_mul_u32_u24 v95, v55, v23
    v_mfma_f32_16x16x32_bf16 v[96:99], v[80:83], v[64:67], 0
    v_mfma_f32_16x16x32_bf16 v[96:99], v[84:87], v[68:71], v[96:99]
    v_mfma_f32_16x16x32_bf16 v[100:103], v[88:91], v[72:75], 0
    v_mfma_f32_16x16x32_bf16 v[100:103], v[92:95], v[76:79], v[100:103]
    v_lshlrev_b32 v52, 16, v52
    v_lshlrev_b32 v53, 16, v53
    v_lshlrev_b32 v54, 16, v54
    v_lshlrev_b32 v55, 16, v55
    v_mul_f32 v41, v52, v145
    v_mul_f32 v43, v54, v153
    v_fmac_f32 v41, v53, v149
    v_fmac_f32 v43, v55, v157
    v_permlane32_swap_b32 v40, v42
    s_nop 0
    v_permlane32_swap_b32 v41, v43
    v_add_f32 v41, v41, v43
    v_xor_b32 v44, v64, v10
    v_xor_b32 v45, v72, v10
    v_bitop3_b32 v44, v65, v11, v44 bitop3:0xbe
    v_bitop3_b32 v45, v73, v11, v45 bitop3:0xbe
    v_bitop3_b32 v44, v66, v12, v44 bitop3:0xbe
    v_bitop3_b32 v45, v74, v12, v45 bitop3:0xbe
    v_bitop3_b32 v44, v67, v13, v44 bitop3:0xbe
    v_bitop3_b32 v45, v75, v13, v45 bitop3:0xbe
    v_bitop3_b32 v44, v68, v10, v44 bitop3:0xbe
    v_bitop3_b32 v45, v76, v10, v45 bitop3:0xbe
    v_bitop3_b32 v44, v69, v11, v44 bitop3:0xbe
    v_bitop3_b32 v45, v77, v11, v45 bitop3:0xbe
    v_bitop3_b32 v44, v70, v12, v44 bitop3:0xbe
    v_bitop3_b32 v45, v78, v12, v45 bitop3:0xbe
    v_bitop3_b32 v44, v71, v13, v44 bitop3:0xbe
    v_bitop3_b32 v45, v79, v13, v45 bitop3:0xbe
    v_add_f32_dpp v41, v41, v41 row_ror:8 row_mask:0xf bank_mask:0xf
    v_permlane32_swap_b32 v96, v100
    v_permlane32_swap_b32 v97, v101
    v_permlane32_swap_b32 v98, v102
    v_permlane32_swap_b32 v99, v103
    v_mov_b32 v43, v41
    v_or_b32 v44, v44, v45
    v_and_or_b32 v37, v44, v14, v37
    v_cmp_ne_u32 vcc, 0, v37
    v_permlane16_swap_b32 v41, v43
    v_add_f32_dpp v96, v100, v96 row_ror:8 row_mask:0xf bank_mask:0xf
    v_add_f32_dpp v97, v101, v97 row_ror:8 row_mask:0xf bank_mask:0xf
    v_add_f32_dpp v98, v102, v98 row_ror:8 row_mask:0xf bank_mask:0xf
    v_add_f32_dpp v99, v103, v99 row_ror:8 row_mask:0xf bank_mask:0xf
    v_add_f32 v41, v41, v43
    s_cbranch_vccz L_d2ok
L_rt:
    s_add_u32 s29, s29, 1
    s_cmp_gt_u32 s29, 1048576
    s_cbranch_scc1 L_d2fail
    s_mov_b32 s95, 0
    v_xor_b32 v44, v64, v10
    v_bitop3_b32 v44, v65, v11, v44 bitop3:0xbe
    v_bitop3_b32 v44, v66, v12, v44 bitop3:0xbe
    v_bitop3_b32 v44, v67, v13, v44 bitop3:0xbe
    v_cmp_ne_u32 vcc, s36, v146
    v_and_b32 v44, v14, v44
    s_nop 1
    v_or_b32_dpp v44, v44, v44 quad_perm:[1,0,3,2] row_mask:0xf bank_mask:0xf
    s_nop 1
    v_or_b32_dpp v44, v44, v44 quad_perm:[2,3,0,1] row_mask:0xf bank_mask:0xf
    s_nop 1
    v_or_b32_dpp v44, v44, v44 row_half_mirror row_mask:0xf bank_mask:0xf
    s_and_b64 exec, vcc, -1
    s_cbranch_execz L_rs9
    s_add_u32 s92, s68, 0
    s_mov_b32 s95, 1
    buffer_load_dwordx3 v[144:146], v250, s[12:15], s92 offen sc1
L_rs9:
    s_mov_b64 exec, -1
    v_cmp_ne_u32 vcc, 0, v44
    s_nop 0
    s_and_b64 exec, vcc, -1
    s_cbranch_execz L_rd10
    s_mov_b32 s95, 1
    buffer_load_dwordx4 v[64:67], v6, s[12:15], s69 offen offset:0 sc1
L_rd10:
    s_mov_b64 exec, -1
    v_xor_b32 v44, v68, v10
    v_bitop3_b32 v44, v69, v11, v44 bitop3:0xbe
    v_bitop3_b32 v44, v70, v12, v44 bitop3:0xbe
    v_bitop3_b32 v44, v71, v13, v44 bitop3:0xbe
    v_cmp_ne_u32 vcc, s36, v150
    v_and_b32 v44, v14, v44
    s_nop 1
    v_or_b32_dpp v44, v44, v44 quad_perm:[1,0,3,2] row_mask:0xf bank_mask:0xf
    s_nop 1
    v_or_b32_dpp v44, v44, v44 quad_perm:[2,3,0,1] row_mask:0xf bank_mask:0xf
    s_nop 1
    v_or_b32_dpp v44, v44, v44 row_half_mirror row_mask:0xf bank_mask:0xf
    s_and_b64 exec, vcc, -1
    s_cbranch_execz L_rs11
    s_add_u32 s92, s68, 4096
    s_mov_b32 s95, 1
    buffer_load_dwordx3 v[148:150], v250, s[12:15], s92 offen sc1
L_rs11:
    s_mov_b64 exec, -1
    v_cmp_ne_u32 vcc, 0, v44
    s_nop 0
    s_and_b64 exec, vcc, -1
    s_cbranch_execz L_rd12
    s_mov_b32 s95, 1
    buffer_load_dwordx4 v[68:71], v6, s[12:15], s69 offen offset:1024 sc1
L_rd12:
    s_mov_b64 exec, -1
    v_xor_b32 v44, v72, v10
    v_bitop3_b32 v44, v73, v11, v44 bitop3:0xbe
    v_bitop3_b32 v44, v74, v12, v44 bitop3:0xbe
    v_bitop3_b32 v44, v75, v13, v44 bitop3:0xbe
    v_cmp_ne_u32 vcc, s36, v154
    v_and_b32 v44, v14, v44
    s_nop 1
    v_or_b32_dpp v44, v44, v44 quad_perm:[1,0,3,2] row_mask:0xf bank_mask:0xf
    s_nop 1
    v_or_b32_dpp v44, v44, v44 quad_perm:[2,3,0,1] row_mask:0xf bank_mask:0xf
    s_nop 1
    v_or_b32_dpp v44, v44, v44 row_half_mirror row_mask:0xf bank_mask:0xf
    s_and_b64 exec, vcc, -1
    s_cbranch_execz L_rs13
    s_add_u32 s92, s68, 8192
    s_mov_b32 s95, 1
    buffer_load_dwordx3 v[152:154], v250, s[12:15], s92 offen sc1
L_rs13:
    s_mov_b64 exec, -1
    v_cmp_ne_u32 vcc, 0, v44
    s_nop 0
    s_and_b64 exec, vcc, -1
    s_cbranch_execz L_rd14
    s_mov_b32 s95, 1
    buffer_load_dwordx4 v[72:75], v6, s[12:15], s69 offen offset:2048 sc1
L_rd14:
    s_mov_b64 exec, -1
    v_xor_b32 v44, v76, v10
    v_bitop3_b32 v44, v77, v11, v44 bitop3:0xbe
    v_bitop3_b32 v44, v78, v12, v44 bitop3:0xbe
    v_bitop3_b32 v44, v79, v13, v44 bitop3:0xbe
    v_cmp_ne_u32 vcc, s36, v158
    v_and_b32 v44, v14, v44
    s_nop 1
    v_or_b32_dpp v44, v44, v44 quad_perm:[1,0,3,2] row_mask:0xf bank_mask:0xf
    s_nop 1
    v_or_b32_dpp v44, v44, v44 quad_perm:[2,3,0,1] row_mask:0xf bank_mask:0xf
    s_nop 1
    v_or_b32_dpp v44, v44, v44 row_half_mirror row_mask:0xf bank_mask:0xf
    s_and_b64 exec, vcc, -1
    s_cbranch_execz L_rs15
    s_add_u32 s92, s68, 12288
    s_mov_b32 s95, 1
    buffer_load_dwordx3 v[156:158], v250, s[12:15], s92 offen sc1
L_rs15:
    s_mov_b64 exec, -1
    v_cmp_ne_u32 vcc, 0, v44
    s_nop 0
    s_and_b64 exec, vcc, -1
    s_cbranch_execz L_rd16
    s_mov_b32 s95, 1
    buffer_load_dwordx4 v[76:79], v6, s[12:15], s69 offen offset:3072 sc1
L_rd16:
    s_mov_b64 exec, -1
    s_cmp_eq_u32 s95, 0
    s_cbranch_scc1 L_h2
    s_waitcnt vmcnt(0)
    s_branch L_rt
L_d2fail:
    v_mov_b32 v60, 12
    v_mov_b32 v61, 1
    s_mov_b64 exec, 1
    global_atomic_add v60, v61, s[88:89]
    s_mov_b64 exec, -1
L_d2ok:
    v_cvt_pk_bf16_f32 v96, v96, v97
    v_cvt_pk_bf16_f32 v97, v98, v99
    s_mov_b32 exec_lo, 0xff00ff
    s_mov_b32 exec_hi, 0xff00ff
    ds_write_b64 v244, v[96:97]
    s_mov_b32 exec_lo, 0x1
    s_mov_b32 exec_hi, 0x1
    ds_write_b64 v240, v[40:41]
    s_mov_b64 exec, -1
    s_mov_b32 s28, 0
    s_mov_b32 s92, 4718592
    s_xor_b32 s70, s70, 4
    s_xor_b32 s4, s37, s70
    s_xor_b32 s5, s38, s70
    s_xor_b32 s6, s39, s70
    s_xor_b32 s71, s40, s70
    s_waitcnt lgkmcnt(0)
    s_barrier
    ds_read_b64 v[40:41], v241
    ds_read_b32 v42, v248
    ds_read_b128 v[64:67], v245
    ds_read_b64_tr_b16 v[160:161], v242
    ds_read_b64_tr_b16 v[162:163], v242 offset:1024
    ds_read_b128 v[68:71], v245 offset:64
    ds_read_b64_tr_b16 v[164:165], v242 offset:8192
    ds_read_b64_tr_b16 v[166:167], v242 offset:9216
    s_waitcnt lgkmcnt(7)
    v_max_f32_dpp v44, v40, v40 row_ror:4 row_mask:0xf bank_mask:0xf
    s_waitcnt lgkmcnt(3)
    v_mfma_f32_16x16x32_bf16 v[72:75], v[64:67], v[160:163], 0
    v_max_f32_dpp v44, v44, v44 row_ror:2 row_mask:0xf bank_mask:0xf
    s_waitcnt lgkmcnt(0)
    v_mfma_f32_16x16x32_bf16 v[72:75], v[68:71], v[164:167], v[72:75]
    v_max_f32_dpp v44, v44, v44 row_ror:1 row_mask:0xf bank_mask:0xf
    v_sub_f32 v40, v40, v44
    v_sub_f32 v42, v42, v44
    v_exp_f32 v40, v40
    v_exp_f32 v42, v42
    v_mul_f32 v40, v40, v41
    s_nop 1
    v_add_f32_dpp v40, v40, v40 row_ror:4 row_mask:0xf bank_mask:0xf
    v_mul_f32_dpp v72, v42, v72 quad_perm:[0,0,0,0] row_mask:0xf bank_mask:0xf
    v_mul_f32_dpp v73, v42, v73 quad_perm:[1,1,1,1] row_mask:0xf bank_mask:0xf
    v_add_f32_dpp v40, v40, v40 row_ror:2 row_mask:0xf bank_mask:0xf
    v_fmac_f32_dpp v72, v42, v74 quad_perm:[2,2,2,2] row_mask:0xf bank_mask:0xf
    v_fmac_f32_dpp v73, v42, v75 quad_perm:[3,3,3,3] row_mask:0xf bank_mask:0xf
    v_add_f32_dpp v40, v40, v40 row_ror:1 row_mask:0xf bank_mask:0xf
    v_add_f32 v72, v72, v73
    v_rcp_f32 v40, v40
    v_mov_b32 v73, v72
    s_nop 1
    v_permlane16_swap_b32 v72, v73
    v_add_f32 v72, v72, v73
    v_mul_f32 v72, v72, v40
    v_bfi_b32 v72, v15, v16, v72
    s_mov_b32 exec_lo, 0xffff
    s_mov_b32 exec_hi, 0xffff
    v_xor_b32 v73, s70, v72
    buffer_store_dword v73, v246, s[12:15], s76 offen
    s_mov_b64 exec, -1
L_c3:
    buffer_load_dwordx4 v[64:67], v19, s[12:15], s92 offen sc1
    s_add_u32 s28, s28, 1
    s_waitcnt vmcnt(0)
    v_xor_b32 v37, s4, v64
    v_bitop3_b32 v37, v65, s5, v37 bitop3:0xbe
    v_bitop3_b32 v37, v66, s6, v37 bitop3:0xbe
    v_bitop3_b32 v37, v67, s71, v37 bitop3:0xbe
    v_cvt_pk_bf16_f32 v64, v64, v65
    v_cvt_pk_bf16_f32 v65, v66, v67
    v_and_b32 v37, v15, v37
    v_cmp_ne_u32 vcc, 0, v37
    s_nop 0
    s_cbranch_vccz L_c3ok
    s_cmp_lt_u32 s28, 12
    s_cbranch_scc1 L_c3
    s_cbranch_scc0 L_c3s
L_c3fail:
    v_mov_b32 v60, 16
    v_mov_b32 v61, 1
    s_mov_b64 exec, 1
    global_atomic_add v60, v61, s[88:89]
    s_mov_b64 exec, -1
L_c3ok:
    s_waitcnt lgkmcnt(0)
    v_mfma_f32_16x16x16_bf16 v[112:115], v[64:65], v[184:185], 0
    v_mfma_f32_16x16x16_bf16 v[116:119], v[64:65], v[186:187], 0
    v_mfma_f32_16x16x16_bf16 v[120:123], v[64:65], v[188:189], 0
    v_mfma_f32_16x16x16_bf16 v[124:127], v[64:65], v[190:191], 0
    s_nop 4
    v_add_f32 v112, v112, v114
    v_add_f32 v113, v113, v115
    v_add_f32 v116, v116, v118
    v_add_f32 v117, v117, v119
    v_add_f32 v120, v120, v122
    v_add_f32 v121, v121, v123
    v_add_f32 v124, v124, v126
    v_add_f32 v125, v125, v127
    v_permlane32_swap_b32 v112, v113
    v_permlane32_swap_b32 v116, v117
    v_permlane32_swap_b32 v120, v121
    v_permlane32_swap_b32 v124, v125
    v_add_f32 v112, v112, v113
    v_add_f32 v116, v116, v117
    v_add_f32 v120, v120, v121
    v_add_f32 v124, v124, v125
    v_permlane16_swap_b32 v112, v116
    s_nop 0
    v_permlane16_swap_b32 v120, v124
    v_add_f32 v112, v112, v116
    v_add_f32 v113, v120, v124
    v_bfi_b32 v112, v15, v16, v112
    v_bfi_b32 v113, v15, v16, v113
    buffer_store_dword v112, v247, s[12:15], s66 offen sc1
    buffer_store_dword v113, v247, s[12:15], s66 offen offset:128 sc1
    s_cmp_ge_u32 s2, 32
    s_cbranch_scc1 L_fin
    v_lshlrev_b32 v36, 12, v5
    v_lshl_add_u32 v36, v4, 4, v36
    s_lshl_b32 s92, s2, 7
    s_lshl_b32 s93, s3, 16
    s_add_u32 s30, s92, s93
    s_add_u32 s31, s30, s93
    s_add_u32 s30, s30, 2097152
    s_add_u32 s31, s31, 1048576
    v_lshlrev_b32 v35, 15, v5
    v_lshl_add_u32 v35, v4, 4, v35
    s_lshl_b32 s31, s3, 20
    s_add_u32 s31, s31, s92
    s_add_u32 s31, s31, 8388608
    s_cmp_eq_u32 s3, 7
    s_cbranch_scc1 L_noy
    s_mov_b32 s92, s30
    buffer_load_dwordx4 v[96:99], v36, s[12:15], s92 offen sc1
    s_add_u32 s92, s92, 32768
    buffer_load_dwordx4 v[100:103], v36, s[12:15], s92 offen sc1
    s_waitcnt vmcnt(2)
    s_mov_b32 s92, s31
    buffer_load_dwordx4 v[64:67], v35, s[12:15], s92 offen sc1
    s_add_u32 s92, s92, 262144
    buffer_load_dwordx4 v[68:71], v35, s[12:15], s92 offen sc1
    s_add_u32 s92, s92, 262144
    buffer_load_dwordx4 v[72:75], v35, s[12:15], s92 offen sc1
    s_add_u32 s92, s92, 262144
    buffer_load_dwordx4 v[76:79], v35, s[12:15], s92 offen sc1
    s_waitcnt vmcnt(4)
    s_mov_b32 s28, 0
L_g17:
    v_xor_b32 v37, s37, v96
    v_xor_b32 v38, s37, v100
    v_bitop3_b32 v37, v97, s38, v37 bitop3:0xbe
    v_bitop3_b32 v38, v101, s38, v38 bitop3:0xbe
    v_bitop3_b32 v37, v98, s39, v37 bitop3:0xbe
    v_bitop3_b32 v38, v102, s39, v38 bitop3:0xbe
    v_bitop3_b32 v37, v99, s40, v37 bitop3:0xbe
    v_bitop3_b32 v38, v103, s40, v38 bitop3:0xbe
    v_or_b32 v37, v37, v38
    v_and_b32 v37, v15, v37
    v_cmp_ne_u32 vcc, 0, v37
    s_nop 0
    s_cbranch_vccz L_gok18
    s_add_u32 s28, s28, 1
    s_cmp_gt_u32 s28, 1048576
    s_cbranch_scc1 L_gf19
    s_mov_b32 s92, s30
    buffer_load_dwordx4 v[96:99], v36, s[12:15], s92 offen sc1
    s_add_u32 s92, s92, 32768
    buffer_load_dwordx4 v[100:103], v36, s[12:15], s92 offen sc1
    s_waitcnt vmcnt(0)
    s_branch L_g17
L_gf19:
    v_mov_b32 v60, 20
    v_mov_b32 v61, 1
    s_mov_b64 exec, 1
    global_atomic_add v60, v61, s[88:89]
    s_mov_b64 exec, -1
L_gok18:
    v_add_f32 v96, v96, v100
    v_add_f32 v97, v97, v101
    v_add_f32 v98, v98, v102
    v_add_f32 v99, v99, v103
    s_branch L_y2
L_noy:
    v_mov_b32 v96, 0
    v_mov_b32 v97, 0
    v_mov_b32 v98, 0
    v_mov_b32 v99, 0
    s_waitcnt vmcnt(0)
    s_mov_b32 s92, s31
    buffer_load_dwordx4 v[64:67], v35, s[12:15], s92 offen sc1
    s_add_u32 s92, s92, 262144
    buffer_load_dwordx4 v[68:71], v35, s[12:15], s92 offen sc1
    s_add_u32 s92, s92, 262144
    buffer_load_dwordx4 v[72:75], v35, s[12:15], s92 offen sc1
    s_add_u32 s92, s92, 262144
    buffer_load_dwordx4 v[76:79], v35, s[12:15], s92 offen sc1
L_y2:
    v_lshlrev_b32 v39, 7, v8
    v_lshl_add_u32 v39, v4, 4, v39
    s_lshl_b32 s92, s3, 8
    s_add_u32 s92, s92, 135168
    v_add_u32 v39, s92, v39
    v_lshlrev_b32 v40, 2, v1
    v_add_u32 v40, 135168, v40
    v_lshlrev_b32 v172, 16, v172
    v_lshlrev_b32 v173, 16, v173
    s_waitcnt vmcnt(0)
    s_mov_b32 s28, 0
L_g20:
    v_xor_b32 v37, s37, v64
    v_xor_b32 v38, s37, v72
    v_bitop3_b32 v37, v65, s38, v37 bitop3:0xbe
    v_bitop3_b32 v38, v73, s38, v38 bitop3:0xbe
    v_bitop3_b32 v37, v66, s39, v37 bitop3:0xbe
    v_bitop3_b32 v38, v74, s39, v38 bitop3:0xbe
    v_bitop3_b32 v37, v67, s40, v37 bitop3:0xbe
    v_bitop3_b32 v38, v75, s40, v38 bitop3:0xbe
    v_bitop3_b32 v37, v68, s37, v37 bitop3:0xbe
    v_bitop3_b32 v38, v76, s37, v38 bitop3:0xbe
    v_bitop3_b32 v37, v69, s38, v37 bitop3:0xbe
    v_bitop3_b32 v38, v77, s38, v38 bitop3:0xbe
    v_bitop3_b32 v37, v70, s39, v37 bitop3:0xbe
    v_bitop3_b32 v38, v78, s39, v38 bitop3:0xbe
    v_bitop3_b32 v37, v71, s40, v37 bitop3:0xbe
    v_bitop3_b32 v38, v79, s40, v38 bitop3:0xbe
    v_or_b32 v37, v37, v38
    v_and_b32 v37, v15, v37
    v_cmp_ne_u32 vcc, 0, v37
    s_nop 0
    s_cbranch_vccz L_gok21
    s_add_u32 s28, s28, 1
    s_cmp_gt_u32 s28, 1048576
    s_cbranch_scc1 L_gf22
    s_mov_b32 s92, s31
    buffer_load_dwordx4 v[64:67], v35, s[12:15], s92 offen sc1
    s_add_u32 s92, s92, 262144
    buffer_load_dwordx4 v[68:71], v35, s[12:15], s92 offen sc1
    s_add_u32 s92, s92, 262144
    buffer_load_dwordx4 v[72:75], v35, s[12:15], s92 offen sc1
    s_add_u32 s92, s92, 262144
    buffer_load_dwordx4 v[76:79], v35, s[12:15], s92 offen sc1
    s_waitcnt vmcnt(0)
    s_branch L_g20
L_gf22:
    v_mov_b32 v60, 24
    v_mov_b32 v61, 1
    s_mov_b64 exec, 1
    global_atomic_add v60, v61, s[88:89]
    s_mov_b64 exec, -1
L_gok21:
    v_add_f32 v64, v64, v68
    v_add_f32 v72, v72, v76
    v_add_f32 v65, v65, v69
    v_add_f32 v73, v73, v77
    v_add_f32 v66, v66, v70
    v_add_f32 v74, v74, v78
    v_add_f32 v67, v67, v71
    v_add_f32 v75, v75, v79
    v_add_f32 v64, v64, v72
    v_add_f32 v65, v65, v73
    v_add_f32 v66, v66, v74
    v_add_f32 v67, v67, v75
    v_permlane32_swap_b32 v64, v96
    v_permlane32_swap_b32 v65, v97
    v_permlane32_swap_b32 v66, v98
    v_permlane32_swap_b32 v67, v99
    v_add_f32 v64, v64, v96
    v_add_f32 v65, v65, v97
    v_add_f32 v66, v66, v98
    v_add_f32 v67, v67, v99
    v_add_f32_dpp v64, v64, v64 row_ror:8 row_mask:0xf bank_mask:0xf
    v_add_f32_dpp v65, v65, v65 row_ror:8 row_mask:0xf bank_mask:0xf
    v_add_f32_dpp v66, v66, v66 row_ror:8 row_mask:0xf bank_mask:0xf
    v_add_f32_dpp v67, v67, v67 row_ror:8 row_mask:0xf bank_mask:0xf
    v_mov_b32 v68, v64
    v_mov_b32 v69, v65
    v_mov_b32 v70, v66
    v_mov_b32 v71, v67
    v_permlane16_swap_b32 v64, v68
    v_permlane16_swap_b32 v65, v69
    v_permlane16_swap_b32 v66, v70
    v_permlane16_swap_b32 v67, v71
    v_add_f32 v64, v64, v68
    v_add_f32 v65, v65, v69
    v_add_f32 v66, v66, v70
    v_add_f32 v67, v67, v71
    s_mov_b32 exec_lo, 0xff
    s_mov_b32 exec_hi, 0xff
    ds_write_b128 v39, v[64:67]
    s_mov_b64 exec, -1
    s_waitcnt lgkmcnt(0)
    s_barrier
    s_cmp_lg_u32 s3, 0
    s_cbranch_scc1 L_fin
    ds_read_b32 v64, v40 offset:0
    ds_read_b32 v65, v40 offset:256
    ds_read_b32 v66, v40 offset:512
    ds_read_b32 v67, v40 offset:768
    ds_read_b32 v68, v40 offset:1024
    ds_read_b32 v69, v40 offset:1280
    ds_read_b32 v70, v40 offset:1536
    ds_read_b32 v71, v40 offset:1792
    s_waitcnt lgkmcnt(4)
    v_add_f32 v64, v64, v65
    v_add_f32 v66, v66, v67
    s_waitcnt lgkmcnt(0)
    v_add_f32 v68, v68, v69
    v_add_f32 v70, v70, v71
    v_add_f32 v64, v64, v66
    v_add_f32 v68, v68, v70
    v_add_f32 v64, v64, v68
    v_cvt_pk_bf16_f32 v64, v64, v64
    v_and_b32 v64, 0xffff0000, v64
    v_mov_b32 v65, v64
    s_nop 1
    v_permlane32_swap_b32 v64, v65
    v_add_f32 v65, v65, v173
    v_cvt_pk_bf16_f32 v65, v65, v65
    v_and_b32 v65, 0xffff0000, v65
    v_mul_f32 v66, 0xbfb8aa3b, v65
    v_exp_f32 v66, v66
    s_nop 0
    v_add_f32 v66, 1.0, v66
    v_rcp_f32 v66, v66
    s_nop 0
    v_mul_f32 v65, v65, v66
    v_cvt_pk_bf16_f32 v65, v65, v65
    v_and_b32 v65, 0xffff0000, v65
    v_mul_f32 v64, v64, v65
    v_cvt_pk_bf16_f32 v64, v64, v64
    v_and_b32 v64, 0xffff0000, v64
    v_add_f32 v64, v64, v172
    v_cvt_pk_bf16_f32 v64, v64, v64
    s_mov_b32 exec_lo, 0xffffffff
    s_mov_b32 exec_hi, 0x0
    global_store_short v171, v64, s[86:87]
    s_cmp_lg_u32 s2, 0
    s_cbranch_scc1 L_noep
    s_mov_b64 exec, 1
    v_mov_b32 v66, s42
    buffer_store_dword v66, v9, s[12:15], 0 offen
L_noep:
    s_mov_b64 exec, -1
L_fin:
L_end:
    s_endpgm
L_c3s:
    s_cmp_lg_u32 s28, 12
    s_cbranch_scc1 L_c3t
    s_mov_b32 exec_lo, 0xffff
    s_mov_b32 exec_hi, 0xffff
    buffer_store_dword v72, v246, s[12:15], s77 offen sc1
    s_mov_b64 exec, -1
L_c3t:
    s_cmp_gt_u32 s28, 1048576
    s_cbranch_scc1 L_c3fail
    s_xor_b32 s92, s92, 786432
    s_xor_b32 s4, s4, s70
    s_xor_b32 s5, s5, s70
    s_xor_b32 s6, s6, s70
    s_xor_b32 s71, s71, s70
    s_branch L_c3
L_codeend:
.section .rodata,"a"
.p2align 6
.amdhsa_kernel recurrent_scan__compressed_kv_cla__dense_activation_gelu__decode_kernel
  .amdhsa_next_free_vgpr 256
  .amdhsa_next_free_sgpr 102
  .amdhsa_accum_offset 256
  .amdhsa_group_segment_fixed_size 0
  .amdhsa_kernarg_size 112
  .amdhsa_user_sgpr_count 2
  .amdhsa_user_sgpr_kernarg_segment_ptr 1
  .amdhsa_system_sgpr_workgroup_id_x 1
  .amdhsa_float_denorm_mode_32 3
.end_amdhsa_kernel
```
